```python
import torch

def _softmax(x, axis=-1):
    return torch.softmax(x, dim=axis)
def _gelu(x):
    return torch.nn.functional.gelu(x, approximate="tanh")
def _silu(x):
    return torch.nn.functional.silu(x)
def _sigmoid(x):
    return torch.sigmoid(x)
def _layernorm(x, axis=-1, eps=1e-5):
    m = x.mean(dim=axis, keepdim=True)
    v = x.var(dim=axis, keepdim=True, unbiased=False)
    return (x - m) / torch.sqrt(v + eps)
def _scatter_add(tgt, idx, src, axis=0):
    return tgt.clone().index_add_(axis, idx, src)
def _segment_sum(src, seg, n):
    out = torch.zeros((n,) + src.shape[1:], dtype=src.dtype)
    return out.index_add_(0, seg, src)
def _pad(x, pw):
    flat = tuple(v for pair in reversed(pw) for v in pair)
    return torch.nn.functional.pad(x, flat)

kernel_name = 'parallel_sum__ssm_conv_s4__mixer_token_mlp__prompt'

def setup_inputs():

    _w = (lambda a: (lambda t: t.to(torch.bfloat16) if t.is_floating_point() else t)(torch.as_tensor(a)))
    def _A_setup():
        B, L, D, N = 1, 2048, 640, 192
        A_re = -(lambda _x: torch.exp(torch.as_tensor(_x)))((lambda *s: torch.randn(*s, dtype=torch.bfloat16) * 6.4)(D, N))
        A_im = torch.pi * (lambda *s: torch.randn(*s, dtype=torch.bfloat16) * 0.05)(D, N)
        B_re = (lambda *s: torch.randn(*s, dtype=torch.bfloat16) * 0.1)(D, N)
        B_im = (lambda *s: torch.randn(*s, dtype=torch.bfloat16) * 0.1)(D, N)
        C_re = (lambda *s: torch.randn(*s, dtype=torch.bfloat16) * 0.1)(D, N)
        C_im = (lambda *s: torch.randn(*s, dtype=torch.bfloat16) * 0.1)(D, N)
        log_dt = (lambda *s: torch.randn(*s, dtype=torch.bfloat16) * 0.05)(D) * 0.5 - 4.0
        Dskip = (lambda *s: torch.randn(*s, dtype=torch.bfloat16) * 0.05)(D)
        return {
            "u": _w((lambda *s: torch.randn(*s, dtype=torch.bfloat16) * 0.05)(B, L, D)),
            "A_re": _w(A_re),
            "A_im": _w(A_im),
            "B_re": _w(B_re),
            "B_im": _w(B_im),
            "C_re": _w(C_re),
            "C_im": _w(C_im),
            "log_dt": _w(log_dt),
            "Dskip": _w(Dskip),
        }
    _A_in = _A_setup()

    def _B_setup():
        B, S, D, F = 1, 2048, 640, 1536
        return {
            "x": _w((lambda *s: torch.randn(*s, dtype=torch.bfloat16) * 0.05)(B, S, D)),
            "w1": _w((lambda *s: torch.randn(*s, dtype=torch.bfloat16) * 0.8)(S, F) * (S ** -0.5)),
            "b1": _w((lambda *s: torch.randn(*s, dtype=torch.bfloat16) * 0.2)(F) * 0.02),
            "w2": _w((lambda *s: torch.randn(*s, dtype=torch.bfloat16) * 0.2)(F, S) * (F ** -0.5)),
            "b2": _w((lambda *s: torch.randn(*s, dtype=torch.bfloat16) * 0.2)(S) * 0.02),
        }
    _B_in = _B_setup()

    return {
        "A_u": _A_in["u"],
        "A_A_re": _A_in["A_re"],
        "A_A_im": _A_in["A_im"],
        "A_B_re": _A_in["B_re"],
        "A_B_im": _A_in["B_im"],
        "A_C_re": _A_in["C_re"],
        "A_C_im": _A_in["C_im"],
        "A_log_dt": _A_in["log_dt"],
        "A_Dskip": _A_in["Dskip"],
        "B_x": _B_in["x"],
        "B_w1": _B_in["w1"],
        "B_b1": _B_in["b1"],
        "B_w2": _B_in["w2"],
        "B_b2": _B_in["b2"],
    }

def reference(A_u, A_A_re, A_A_im, A_B_re, A_B_im, A_C_re, A_C_im, A_log_dt, A_Dskip, B_x, B_w1, B_b1, B_w2, B_b2):
    def _A_ref(u, A_re, A_im, B_re, B_im, C_re, C_im, log_dt, Dskip):
        Bsz, L, D = u.shape
        dt = torch.exp(log_dt)[:, None]
        A = A_re + 1j * A_im
        Bc = B_re + 1j * B_im
        Cc = C_re + 1j * C_im
        logdA = dt * A
        dB = dt * Bc
        l = (lambda x, dt: x.to(dt))(torch.arange(L), A_re.dtype)
        P = torch.exp(logdA[:, :, None] * l[None, None, :])
        K = torch.einsum("dn,dnl,dn->dl", Cc, P, dB).real
        L2 = 2 * L
        Kp = _pad(K, ((0, 0), (0, L)))
        up = (lambda x, *d: x.permute(*d))(u, 0, 2, 1)
        up = _pad(up, ((0, 0), (0, 0), (0, L)))
        Kf = (lambda x, axes=(-2,-1): torch.fft.rfft2(x.float(), dim=axes))(Kp[:, None, :], axes=(-2, -1))
        Uf = (lambda x, axes=(-2,-1): torch.fft.rfft2(x.float(), dim=axes))(up[:, :, None, :], axes=(-2, -1))
        Yf = Uf * Kf[None, :, :, :]
        y = (lambda x, s, axes=(-2,-1): torch.fft.irfft2(x, s=s, dim=axes).to(torch.bfloat16))(Yf, (1, L2), axes=(-2, -1))[:, :, 0, :L]
        y = (lambda x, *d: x.permute(*d))(y, 0, 2, 1) + u * Dskip[None, None, :]
        return y

    def _B_ref(x, w1, b1, w2, b2):
        B, S, D = x.shape
        h = _layernorm(x, axis=-1)
        u = torch.einsum("bsd,sf->bdf", h, w1) + b1
        u = _gelu(u)
        y = torch.einsum("bdf,fs->bds", u, w2) + b2
        return (lambda x, *d: x.permute(*d))(y, 0, 2, 1)

    x = A_u
    xn = _layernorm(x, axis=-1)
    return x + _A_ref(xn, A_A_re, A_A_im, A_B_re, A_B_im, A_C_re, A_C_im, A_log_dt, A_Dskip) + _B_ref(xn, B_w1, B_b1, B_w2, B_b2)
```

```asm
; @launch grid=(256,1,1) block=(512,1,1) lds=163840
.amdgcn_target "amdgcn-amd-amdhsa--gfx950"
.text
.globl parallel_sum__ssm_conv_s4__mixer_token_mlp__prompt_kernel
.p2align 8
.type parallel_sum__ssm_conv_s4__mixer_token_mlp__prompt_kernel,@function
parallel_sum__ssm_conv_s4__mixer_token_mlp__prompt_kernel:
    s_cmp_ge_u32 s2, 256
    s_cbranch_scc1 L_exit
    s_load_dwordx16 s[16:31], s[0:1], 0
    s_load_dwordx16 s[32:47], s[0:1], 64
    s_load_dwordx2 s[48:49], s[0:1], 128
    v_lshrrev_b32 v1, 6, v0
    v_and_b32 v0, 63, v0
    v_readfirstlane_b32 s3, v1
    v_lshlrev_b32 v2, 4, v0
    v_lshlrev_b32 v3, 2, v0
    s_getpc_b64 s[72:73]
L_pc:
    s_and_b32 s4, s2, 7
    s_lshr_b32 s5, s2, 3
    s_mov_b32 s13, 0xffff0000
    s_and_b32 s73, s73, 0xffff
    s_mov_b32 s74, L_code_end-L_pc
    s_mov_b32 s75, 0x20000
    s_cmp_lg_u32 s3, 7
    s_cbranch_scc1 L_nopf
    s_lshl_b32 s8, s5, 7
    v_lshlrev_b32 v1, 12, v0
    buffer_load_dword v14, v1, s[72:75], s8 offen
    v_mov_b32 v21, 47968
    v_mov_b32 v24, 0
    v_mov_b32 v25, 0
    v_mov_b32 v26, 0
    v_mov_b32 v27, 0
    ds_write_b128 v21, v[24:27]
    ds_write_b128 v21, v[24:27] offset:16
    ds_write_b128 v21, v[24:27] offset:32
    ds_write_b128 v21, v[24:27] offset:48
L_nopf:
    v_mov_b32 v7, 0
    v_mov_b32 v8, 0
    s_and_b32 s8, s3, 3
    s_cmp_eq_u32 s3, 7
    s_cselect_b32 s8, 0, s8
    s_mul_i32 s95, s8, 12576
    s_lshr_b32 s9, s5, 1
    s_mul_i32 s9, s9, 5
    s_and_b32 s10, s5, 1
    s_mul_i32 s10, s10, 3
    s_add_u32 s9, s9, s10
    s_add_u32 s9, s9, s8
    s_min_u32 s9, s9, 79
    s_and_b32 s10, s9, 35
    s_and_b32 s11, s9, 12
    s_lshl_b32 s11, s11, 1
    s_or_b32 s10, s10, s11
    s_and_b32 s11, s9, 16
    s_lshr_b32 s11, s11, 2
    s_or_b32 s10, s10, s11
    s_cmp_ge_u32 s9, 64
    s_cselect_b32 s10, s9, s10
    s_mul_i32 s11, s4, 80
    s_add_u32 s93, s11, s9
    s_add_u32 s94, s11, s10
    s_mul_i32 s8, s94, 384
    v_add_u32 v10, s8, v3
    v_lshlrev_b32 v11, 1, v0
    v_add_u32 v11, s8, v11
    s_lshl_b32 s8, s94, 1
    v_mov_b32 v12, s8
    s_lshl_b32 s8, s2, 2
    s_add_u32 s8, s8, s3
    s_mul_i32 s8, s8, 2560
    s_mov_b32 s58, 0x280000
    s_mov_b32 s59, 0x20000
    s_mov_b32 s54, 0xc00000
    s_mov_b32 s55, 0x20000
    s_mov_b32 s62, 0x600000
    s_mov_b32 s63, 0x20000
    s_mov_b32 s66, 0x600000
    s_mov_b32 s67, 0x20000
    s_mov_b32 s70, 0x280000
    s_mov_b32 s71, 0x20000
    s_mul_i32 s10, s3, 1408
    s_add_u32 s10, s10, 65536
    v_add_u32 v61, 28032, v2
    v_cmp_gt_u32 vcc, 40, v0
    s_nop 1
    v_cndmask_b32 v60, v61, v2, vcc
    v_add_u32 v60, s10, v60
    s_add_u32 s10, s10, 29056
    v_add_u32 v61, s10, v3
    s_lshl_b32 s10, s3, 3
    s_add_u32 s10, s10, 48032
    v_mov_b32 v59, s10
    s_cmp_ge_u32 s3, 4
    s_waitcnt lgkmcnt(0)
    s_cbranch_scc1 L_nox
    s_mov_b32 s56, s16
    s_and_b32 s57, s17, 0xffff
    buffer_load_dwordx4 v[16:19], v2, s[56:59], s8 offen
    buffer_load_dword v20, v3, s[56:59], s8 offen offset:1024
    buffer_load_dwordx4 v[64:67], v2, s[56:59], s8 offen offset:1280
    buffer_load_dword v68, v3, s[56:59], s8 offen offset:2304
L_nox:
    s_cmp_lt_u32 s3, 4
    s_cbranch_scc1 L_gemm_pre
    s_cmp_eq_u32 s3, 7
    s_cbranch_scc1 L_w7_pre
    global_load_dword v84, v10, s[18:19]
    global_load_ushort v90, v11, s[18:19] offset:256
    global_load_dword v85, v10, s[20:21]
    global_load_ushort v91, v11, s[20:21] offset:256
    global_load_dword v86, v10, s[22:23]
    global_load_ushort v92, v11, s[22:23] offset:256
    global_load_dword v87, v10, s[24:25]
    global_load_ushort v93, v11, s[24:25] offset:256
    global_load_dword v88, v10, s[26:27]
    global_load_ushort v94, v11, s[26:27] offset:256
    global_load_dword v89, v10, s[28:29]
    global_load_ushort v95, v11, s[28:29] offset:256
    global_load_ushort v96, v12, s[30:31]
    global_load_ushort v97, v12, s[32:33]
    s_mov_b32 s52, s48
    s_and_b32 s53, s49, 0xffff
    s_barrier
    s_branch L_aux_main
L_w7_pre:
    s_add_u32 s14, s48, 0xa60000
    s_addc_u32 s15, s49, 0
    s_load_dword s7, s[14:15], 0
    s_mov_b32 s52, s48
    s_and_b32 s53, s49, 0xffff
    s_mov_b32 s60, s36
    s_and_b32 s61, s37, 0xffff
    s_mov_b32 s64, s40
    s_and_b32 s65, s41, 0xffff
    s_mov_b32 s68, s44
    s_and_b32 s69, s45, 0xffff
    v_lshrrev_b32 v10, 4, v0
    v_and_b32 v11, 3, v0
    v_bfe_u32 v12, v0, 2, 2
    s_movk_i32 s8, 704
    v_mul_lo_u32 v12, v12, s8
    v_add_u32 v12, 65536, v12
    v_add_u32 v21, 0, v10
    v_mul_u32_u24 v22, 13, v21
    v_lshrrev_b32 v22, 6, v22
    v_mul_u32_u24 v23, 5, v22
    v_sub_u32 v21, v21, v23
    v_lshrrev_b32 v23, 1, v21
    v_lshlrev_b32 v23, 5, v23
    v_and_b32 v24, 1, v21
    v_lshl_add_u32 v23, v24, 2, v23
    v_lshlrev_b32 v24, 3, v11
    v_lshlrev_b32 v25, 2, v11
    v_cmp_eq_u32 vcc, 4, v21
    s_nop 1
    v_cndmask_b32 v24, v24, v25, vcc
    v_add_u32 v23, v23, v24
    v_mul_u32_u24 v22, 80, v22
    v_add_u32 v23, v23, v22
    v_lshl_add_u32 v4, v23, 1, v12
    v_add_u32 v21, 4, v10
    v_mul_u32_u24 v22, 13, v21
    v_lshrrev_b32 v22, 6, v22
    v_mul_u32_u24 v23, 5, v22
    v_sub_u32 v21, v21, v23
    v_lshrrev_b32 v23, 1, v21
    v_lshlrev_b32 v23, 5, v23
    v_and_b32 v24, 1, v21
    v_lshl_add_u32 v23, v24, 2, v23
    v_lshlrev_b32 v24, 3, v11
    v_lshlrev_b32 v25, 2, v11
    v_cmp_eq_u32 vcc, 4, v21
    s_nop 1
    v_cndmask_b32 v24, v24, v25, vcc
    v_add_u32 v23, v23, v24
    v_mul_u32_u24 v22, 80, v22
    v_add_u32 v23, v23, v22
    v_lshl_add_u32 v5, v23, 1, v12
    v_add_u32 v21, 8, v10
    v_mul_u32_u24 v22, 13, v21
    v_lshrrev_b32 v22, 6, v22
    v_mul_u32_u24 v23, 5, v22
    v_sub_u32 v21, v21, v23
    v_lshrrev_b32 v23, 1, v21
    v_lshlrev_b32 v23, 5, v23
    v_and_b32 v24, 1, v21
    v_lshl_add_u32 v23, v24, 2, v23
    v_lshlrev_b32 v24, 3, v11
    v_lshlrev_b32 v25, 2, v11
    v_cmp_eq_u32 vcc, 4, v21
    s_nop 1
    v_cndmask_b32 v24, v24, v25, vcc
    v_add_u32 v23, v23, v24
    v_mul_u32_u24 v22, 80, v22
    v_add_u32 v23, v23, v22
    v_lshl_add_u32 v6, v23, 1, v12
    v_add_u32 v21, 12, v10
    v_mul_u32_u24 v22, 13, v21
    v_lshrrev_b32 v22, 6, v22
    v_mul_u32_u24 v23, 5, v22
    v_sub_u32 v21, v21, v23
    v_lshrrev_b32 v23, 1, v21
    v_lshlrev_b32 v23, 5, v23
    v_and_b32 v24, 1, v21
    v_lshl_add_u32 v23, v24, 2, v23
    v_lshlrev_b32 v24, 3, v11
    v_lshlrev_b32 v25, 2, v11
    v_cmp_eq_u32 vcc, 4, v21
    s_nop 1
    v_cndmask_b32 v24, v24, v25, vcc
    v_add_u32 v23, v23, v24
    v_mul_u32_u24 v22, 80, v22
    v_add_u32 v23, v23, v22
    v_lshl_add_u32 v7, v23, 1, v12
    v_add_u32 v21, 16, v10
    v_mul_u32_u24 v22, 13, v21
    v_lshrrev_b32 v22, 6, v22
    v_mul_u32_u24 v23, 5, v22
    v_sub_u32 v21, v21, v23
    v_lshrrev_b32 v23, 1, v21
    v_lshlrev_b32 v23, 5, v23
    v_and_b32 v24, 1, v21
    v_lshl_add_u32 v23, v24, 2, v23
    v_lshlrev_b32 v24, 3, v11
    v_lshlrev_b32 v25, 2, v11
    v_cmp_eq_u32 vcc, 4, v21
    s_nop 1
    v_cndmask_b32 v24, v24, v25, vcc
    v_add_u32 v23, v23, v24
    v_mul_u32_u24 v22, 80, v22
    v_add_u32 v23, v23, v22
    v_lshl_add_u32 v8, v23, 1, v12
    s_setprio 3
    s_barrier
    v_mov_b32 v12, 47976
    s_mov_b32 s12, 0x200000
L_lw0:
    ds_read_b32 v13, v12
    s_waitcnt lgkmcnt(0)
    v_readfirstlane_b32 s8, v13
    s_nop 0
    s_cmp_ge_u32 s8, 4
    s_cbranch_scc1 L_lwok0
    s_sub_u32 s12, s12, 1
    s_cmp_lg_u32 s12, 0
    s_cbranch_scc1 L_lw0
L_lwok0:
    s_add_u32 s6, s7, 0x9E3779B9
    s_branch L_pub
L_gemm_pre:
    s_mov_b32 s56, s16
    s_and_b32 s57, s17, 0xffff
    s_add_u32 s14, s48, 0xa60000
    s_addc_u32 s15, s49, 0
    s_load_dword s7, s[14:15], 0
    s_mov_b32 s52, s48
    s_and_b32 s53, s49, 0xffff
    s_mov_b32 s60, s36
    s_and_b32 s61, s37, 0xffff
    s_mov_b32 s64, s40
    s_and_b32 s65, s41, 0xffff
    s_mov_b32 s68, s44
    s_and_b32 s69, s45, 0xffff
    s_and_b32 s8, s4, 1
    s_lshr_b32 s9, s4, 1
    v_mul_u32_u24 v62, 3072, v0
    s_mul_i32 s96, s5, 196608
    s_mul_i32 s10, s5, 26
    s_lshr_b32 s10, s10, 8
    s_mul_i32 s11, s10, 10
    s_sub_u32 s11, s5, s11
    s_mov_b32 s76, s11
    s_mul_i32 s77, s4, 3
    s_add_u32 s97, s77, s3
    s_lshl_b32 s97, s97, 7
    s_add_u32 s96, s96, s97
    s_cmp_ge_u32 s3, 3
    s_cselect_b32 s96, 0x7f000000, s96
    s_add_u32 s77, s77, s10
    s_mul_i32 s97, s11, 410
    s_lshr_b32 s97, s97, 8
    s_mul_i32 s14, s4, 2
    s_add_u32 s97, s97, s14
    s_mul_i32 s14, s10, 0
    s_add_u32 s97, s97, s14
    s_and_b32 s97, s97, 15
    s_lshl_b32 s97, s97, 2
    s_mov_b32 s100, 0x76543210
    s_mov_b32 s101, 0xfedcba98
    s_lshr_b64 s[50:51], s[100:101], s97
    s_sub_u32 s97, 64, s97
    s_lshl_b64 s[100:101], s[100:101], s97
    s_or_b64 s[50:51], s[50:51], s[100:101]
    s_and_b32 s10, s5, 7
    s_lshr_b32 s11, s5, 3
    s_mov_b32 s78, s10
    s_lshl_b32 s79, s4, 2
    s_add_u32 s79, s79, s11
    s_mul_i32 s97, s10, 3
    s_mul_i32 s14, s4, 3
    s_add_u32 s97, s97, s14
    s_mul_i32 s14, s11, 0
    s_add_u32 s97, s97, s14
    s_lshr_b32 s97, s97, 1
    s_mul_i32 s14, s97, 43
    s_lshr_b32 s14, s14, 9
    s_mul_i32 s14, s14, 12
    s_sub_u32 s97, s97, s14
    s_mov_b32 s91, 0x76543210
    s_mov_b32 s92, 0xba98
    s_cmp_eq_u32 s97, 1
    s_cselect_b32 s91, 0x87654321, s91
    s_cselect_b32 s92, 0xba9, s92
    s_cmp_eq_u32 s97, 2
    s_cselect_b32 s91, 0x98765432, s91
    s_cselect_b32 s92, 0x10ba, s92
    s_cmp_eq_u32 s97, 3
    s_cselect_b32 s91, 0xa9876543, s91
    s_cselect_b32 s92, 0x210b, s92
    s_cmp_eq_u32 s97, 4
    s_cselect_b32 s91, 0xba987654, s91
    s_cselect_b32 s92, 0x3210, s92
    s_cmp_eq_u32 s97, 5
    s_cselect_b32 s91, 0xba98765, s91
    s_cselect_b32 s92, 0x4321, s92
    s_cmp_eq_u32 s97, 6
    s_cselect_b32 s91, 0x10ba9876, s91
    s_cselect_b32 s92, 0x5432, s92
    s_cmp_eq_u32 s97, 7
    s_cselect_b32 s91, 0x210ba987, s91
    s_cselect_b32 s92, 0x6543, s92
    s_cmp_eq_u32 s97, 8
    s_cselect_b32 s91, 0x3210ba98, s91
    s_cselect_b32 s92, 0x7654, s92
    s_cmp_eq_u32 s97, 9
    s_cselect_b32 s91, 0x43210ba9, s91
    s_cselect_b32 s92, 0x8765, s92
    s_cmp_eq_u32 s97, 10
    s_cselect_b32 s91, 0x543210ba, s91
    s_cselect_b32 s92, 0x9876, s92
    s_cmp_eq_u32 s97, 11
    s_cselect_b32 s91, 0x6543210b, s91
    s_cselect_b32 s92, 0xa987, s92
    s_mov_b32 exec_hi, 0
    s_mov_b32 s72, s38
    s_and_b32 s73, s39, 0xffff
    s_mov_b32 s74, 0xc00
    s_mov_b32 s75, 0x20000
    s_lshl_b32 s8, s77, 7
    s_mov_b32 m0, 48064
    s_nop 0
    buffer_load_dword v3, s[72:75], s8 offen lds
    s_mov_b32 s72, s42
    s_and_b32 s73, s43, 0xffff
    s_mov_b32 s74, 0x1000
    s_mov_b32 s75, 0x20000
    s_lshl_b32 s8, s79, 7
    s_mov_b32 m0, 48192
    s_nop 0
    buffer_load_dword v3, s[72:75], s8 offen lds
    s_mov_b64 exec, -1
    s_setprio 2
    s_mul_i32 s80, s3, 28672
    s_add_u32 s80, s80, 49152
    v_lshrrev_b32 v10, 3, v0
    v_and_b32 v11, 6, v10
    v_and_b32 v12, 7, v0
    v_xor_b32 v12, v12, v11
    v_lshlrev_b32 v12, 4, v12
    v_and_b32 v11, 4, v10
    v_add_u32 v10, v10, v11
    s_mov_b32 s8, 3072
    v_mul_lo_u32 v10, v10, s8
    v_add_u32 v7, v10, v12
    s_mul_i32 s82, s3, 1572864
    s_lshl_b32 s8, s77, 7
    s_add_u32 s82, s82, s8
    s_cmp_ge_u32 s5, 30
    s_cselect_b32 s82, 0x7f000000, s82
    s_barrier
    s_waitcnt vmcnt(2)
    s_bfe_u32 s81, s50, 0x40000
    s_mul_i32 s81, s81, 98304
    s_add_u32 s81, s81, s82
    s_add_u32 m0, s80, 0
    s_nop 0
    buffer_load_dwordx4 v7, s[60:63], s81 offen  lds
    s_add_u32 m0, s80, 1024
    s_add_u32 s8, s81, 49152
    buffer_load_dwordx4 v7, s[60:63], s8 offen  lds
    s_add_u32 m0, s80, 2048
    s_add_u32 s8, s81, 12288
    buffer_load_dwordx4 v7, s[60:63], s8 offen  lds
    s_add_u32 m0, s80, 3072
    s_add_u32 s8, s81, 61440
    buffer_load_dwordx4 v7, s[60:63], s8 offen  lds
L_ln:
    v_lshlrev_b32 v24, 16, v16
    v_lshlrev_b32 v72, 16, v64
    v_and_b32 v25, s13, v16
    v_and_b32 v73, s13, v64
    v_lshlrev_b32 v26, 16, v17
    v_lshlrev_b32 v74, 16, v65
    v_and_b32 v27, s13, v17
    v_and_b32 v75, s13, v65
    v_lshlrev_b32 v28, 16, v18
    v_lshlrev_b32 v76, 16, v66
    v_and_b32 v29, s13, v18
    v_and_b32 v77, s13, v66
    v_lshlrev_b32 v30, 16, v19
    v_lshlrev_b32 v78, 16, v67
    v_and_b32 v31, s13, v19
    v_and_b32 v79, s13, v67
    v_lshlrev_b32 v32, 16, v20
    v_lshlrev_b32 v80, 16, v68
    v_and_b32 v33, s13, v20
    v_and_b32 v81, s13, v68
    v_readfirstlane_b32 s14, v24
    v_readfirstlane_b32 s15, v72
    v_mov_b32 v54, 0x3acccccd
    v_mov_b32 v102, 0x3acccccd
    v_mov_b32 v34, s14
    v_mov_b32 v82, s15
    v_pk_add_f32 v[24:25], v[24:25], v[34:35] op_sel_hi:[1,0] neg_lo:[0,1] neg_hi:[0,1]
    v_pk_add_f32 v[72:73], v[72:73], v[82:83] op_sel_hi:[1,0] neg_lo:[0,1] neg_hi:[0,1]
    v_pk_add_f32 v[26:27], v[26:27], v[34:35] op_sel_hi:[1,0] neg_lo:[0,1] neg_hi:[0,1]
    v_pk_add_f32 v[74:75], v[74:75], v[82:83] op_sel_hi:[1,0] neg_lo:[0,1] neg_hi:[0,1]
    v_pk_add_f32 v[28:29], v[28:29], v[34:35] op_sel_hi:[1,0] neg_lo:[0,1] neg_hi:[0,1]
    v_pk_add_f32 v[76:77], v[76:77], v[82:83] op_sel_hi:[1,0] neg_lo:[0,1] neg_hi:[0,1]
    v_pk_add_f32 v[30:31], v[30:31], v[34:35] op_sel_hi:[1,0] neg_lo:[0,1] neg_hi:[0,1]
    v_pk_add_f32 v[78:79], v[78:79], v[82:83] op_sel_hi:[1,0] neg_lo:[0,1] neg_hi:[0,1]
    v_pk_add_f32 v[32:33], v[32:33], v[34:35] op_sel_hi:[1,0] neg_lo:[0,1] neg_hi:[0,1]
    v_pk_add_f32 v[80:81], v[80:81], v[82:83] op_sel_hi:[1,0] neg_lo:[0,1] neg_hi:[0,1]
    v_pk_mul_f32 v[36:37], v[24:25], v[24:25]
    v_pk_mul_f32 v[84:85], v[72:73], v[72:73]
    v_pk_add_f32 v[34:35], v[24:25], v[26:27]
    v_pk_add_f32 v[82:83], v[72:73], v[74:75]
    v_pk_mul_f32 v[40:41], v[28:29], v[28:29]
    v_pk_mul_f32 v[88:89], v[76:77], v[76:77]
    v_pk_add_f32 v[38:39], v[28:29], v[30:31]
    v_pk_add_f32 v[86:87], v[76:77], v[78:79]
    v_pk_fma_f32 v[36:37], v[26:27], v[26:27], v[36:37]
    v_pk_fma_f32 v[84:85], v[74:75], v[74:75], v[84:85]
    v_pk_add_f32 v[34:35], v[34:35], v[32:33]
    v_pk_add_f32 v[82:83], v[82:83], v[80:81]
    v_pk_fma_f32 v[40:41], v[30:31], v[30:31], v[40:41]
    v_pk_fma_f32 v[88:89], v[78:79], v[78:79], v[88:89]
    v_pk_fma_f32 v[36:37], v[32:33], v[32:33], v[36:37]
    v_pk_fma_f32 v[84:85], v[80:81], v[80:81], v[84:85]
    v_pk_add_f32 v[34:35], v[34:35], v[38:39]
    v_pk_add_f32 v[82:83], v[82:83], v[86:87]
    v_pk_add_f32 v[36:37], v[36:37], v[40:41]
    v_pk_add_f32 v[84:85], v[84:85], v[88:89]
    v_add_f32 v34, v34, v35
    v_add_f32 v82, v82, v83
    v_add_f32 v36, v36, v37
    v_add_f32 v84, v84, v85
    v_add_f32_dpp v34, v34, v34 row_shr:1 row_mask:0xf bank_mask:0xf bound_ctrl:0
    v_add_f32_dpp v82, v82, v82 row_shr:1 row_mask:0xf bank_mask:0xf bound_ctrl:0
    v_add_f32_dpp v36, v36, v36 row_shr:1 row_mask:0xf bank_mask:0xf bound_ctrl:0
    v_add_f32_dpp v84, v84, v84 row_shr:1 row_mask:0xf bank_mask:0xf bound_ctrl:0
    v_add_f32_dpp v34, v34, v34 row_shr:2 row_mask:0xf bank_mask:0xf bound_ctrl:0
    v_add_f32_dpp v82, v82, v82 row_shr:2 row_mask:0xf bank_mask:0xf bound_ctrl:0
    v_add_f32_dpp v36, v36, v36 row_shr:2 row_mask:0xf bank_mask:0xf bound_ctrl:0
    v_add_f32_dpp v84, v84, v84 row_shr:2 row_mask:0xf bank_mask:0xf bound_ctrl:0
    v_add_f32_dpp v34, v34, v34 row_shr:4 row_mask:0xf bank_mask:0xf bound_ctrl:0
    v_add_f32_dpp v82, v82, v82 row_shr:4 row_mask:0xf bank_mask:0xf bound_ctrl:0
    v_add_f32_dpp v36, v36, v36 row_shr:4 row_mask:0xf bank_mask:0xf bound_ctrl:0
    v_add_f32_dpp v84, v84, v84 row_shr:4 row_mask:0xf bank_mask:0xf bound_ctrl:0
    v_add_f32_dpp v34, v34, v34 row_shr:8 row_mask:0xf bank_mask:0xf bound_ctrl:0
    v_add_f32_dpp v82, v82, v82 row_shr:8 row_mask:0xf bank_mask:0xf bound_ctrl:0
    v_add_f32_dpp v36, v36, v36 row_shr:8 row_mask:0xf bank_mask:0xf bound_ctrl:0
    v_add_f32_dpp v84, v84, v84 row_shr:8 row_mask:0xf bank_mask:0xf bound_ctrl:0
    v_add_f32_dpp v34, v34, v34 row_bcast:15 row_mask:0xa bank_mask:0xf
    v_add_f32_dpp v82, v82, v82 row_bcast:15 row_mask:0xa bank_mask:0xf
    v_add_f32_dpp v36, v36, v36 row_bcast:15 row_mask:0xa bank_mask:0xf
    v_add_f32_dpp v84, v84, v84 row_bcast:15 row_mask:0xa bank_mask:0xf
    v_add_f32_dpp v34, v34, v34 row_bcast:31 row_mask:0xc bank_mask:0xf
    v_add_f32_dpp v82, v82, v82 row_bcast:31 row_mask:0xc bank_mask:0xf
    v_add_f32_dpp v36, v36, v36 row_bcast:31 row_mask:0xc bank_mask:0xf
    v_add_f32_dpp v84, v84, v84 row_bcast:31 row_mask:0xc bank_mask:0xf
    v_readlane_b32 s8, v34, 63
    v_readlane_b32 s10, v82, 63
    v_readlane_b32 s9, v36, 63
    v_readlane_b32 s11, v84, 63
    v_mul_f32 v50, s8, v54
    v_mul_f32 v98, s10, v102
    v_mul_f32 v51, s9, v54
    v_mul_f32 v99, s11, v102
    v_fma_f32 v51, -v50, v50, v51
    v_fma_f32 v99, -v98, v98, v99
    v_add_f32 v34, s14, v50
    v_add_f32 v82, s15, v98
    v_max_f32 v51, 0, v51
    v_max_f32 v99, 0, v99
    v_cvt_pk_bf16_f32 v38, v34, v51
    v_cvt_pk_bf16_f32 v86, v82, v99
    v_and_b32 v52, s13, v38
    v_and_b32 v100, s13, v86
    v_lshlrev_b32 v36, 16, v38
    v_lshlrev_b32 v84, 16, v86
    v_add_f32 v52, 0x3727c5ac, v52
    v_add_f32 v100, 0x3727c5ac, v100
    v_cvt_pk_bf16_f32 v52, v52, v52
    v_cvt_pk_bf16_f32 v100, v100, v100
    v_and_b32 v52, s13, v52
    v_and_b32 v100, s13, v100
    v_sqrt_f32 v52, v52
    v_sqrt_f32 v100, v100
    v_cvt_pk_bf16_f32 v52, v52, v52
    v_cvt_pk_bf16_f32 v100, v100, v100
    v_and_b32 v52, s13, v52
    v_and_b32 v100, s13, v100
    v_rcp_f32 v52, v52
    v_rcp_f32 v100, v100
    v_sub_f32 v36, s14, v36
    v_sub_f32 v84, s15, v84
    v_mul_f32 v51, v51, v52
    v_mul_f32 v99, v99, v100
    v_mul_f32 v53, v36, v52
    v_mul_f32 v101, v84, v100
    v_mul_f32 v40, v36, v52
    v_mul_f32 v88, v84, v100
    v_mul_f32 v41, v36, v52
    v_mul_f32 v89, v84, v100
    v_mul_f32 v51, v51, v52
    v_mul_f32 v99, v99, v100
    v_fma_f32 v34, v50, v52, v53
    v_fma_f32 v82, v98, v100, v101
    v_cvt_pk_bf16_f32 v38, v34, v51
    v_cvt_pk_bf16_f32 v86, v82, v99
    v_pk_fma_f32 v[24:25], v[24:25], v[52:53], v[40:41] op_sel_hi:[1,0,1]
    v_pk_fma_f32 v[72:73], v[72:73], v[100:101], v[88:89] op_sel_hi:[1,0,1]
    v_and_b32 v54, s13, v38
    v_and_b32 v102, s13, v86
    v_pk_fma_f32 v[26:27], v[26:27], v[52:53], v[40:41] op_sel_hi:[1,0,1]
    v_pk_fma_f32 v[74:75], v[74:75], v[100:101], v[88:89] op_sel_hi:[1,0,1]
    v_lshlrev_b32 v36, 16, v38
    v_lshlrev_b32 v84, 16, v86
    v_pk_fma_f32 v[28:29], v[28:29], v[52:53], v[40:41] op_sel_hi:[1,0,1]
    v_pk_fma_f32 v[76:77], v[76:77], v[100:101], v[88:89] op_sel_hi:[1,0,1]
    v_add_f32 v54, 0x3727c5ac, v54
    v_add_f32 v102, 0x3727c5ac, v102
    v_pk_fma_f32 v[30:31], v[30:31], v[52:53], v[40:41] op_sel_hi:[1,0,1]
    v_pk_fma_f32 v[78:79], v[78:79], v[100:101], v[88:89] op_sel_hi:[1,0,1]
    v_cvt_pk_bf16_f32 v54, v54, v54
    v_cvt_pk_bf16_f32 v102, v102, v102
    v_pk_fma_f32 v[32:33], v[32:33], v[52:53], v[40:41] op_sel_hi:[1,0,1]
    v_pk_fma_f32 v[80:81], v[80:81], v[100:101], v[88:89] op_sel_hi:[1,0,1]
    v_and_b32 v54, s13, v54
    v_and_b32 v102, s13, v102
    v_sqrt_f32 v54, v54
    v_sqrt_f32 v102, v102
    v_cvt_pk_bf16_f32 v54, v54, v54
    v_cvt_pk_bf16_f32 v102, v102, v102
    v_and_b32 v54, s13, v54
    v_and_b32 v102, s13, v102
    v_lshrrev_b32 v38, 16, v36
    v_lshrrev_b32 v86, 16, v84
    v_or_b32 v38, v38, v54
    v_or_b32 v86, v86, v102
    ds_write_b32 v59, v38 offset:0
    ds_write_b32 v59, v86 offset:4
    v_rcp_f32 v54, v54
    v_rcp_f32 v102, v102
    v_mul_f32 v42, v36, v54
    v_mul_f32 v90, v84, v102
    v_mul_f32 v43, v36, v54
    v_mul_f32 v91, v84, v102
    v_pk_fma_f32 v[24:25], v[24:25], v[54:55], v[42:43] op_sel_hi:[1,0,1] neg_lo:[0,0,1] neg_hi:[0,0,1]
    v_pk_fma_f32 v[72:73], v[72:73], v[102:103], v[90:91] op_sel_hi:[1,0,1] neg_lo:[0,0,1] neg_hi:[0,0,1]
    v_pk_fma_f32 v[26:27], v[26:27], v[54:55], v[42:43] op_sel_hi:[1,0,1] neg_lo:[0,0,1] neg_hi:[0,0,1]
    v_pk_fma_f32 v[74:75], v[74:75], v[102:103], v[90:91] op_sel_hi:[1,0,1] neg_lo:[0,0,1] neg_hi:[0,0,1]
    v_pk_fma_f32 v[28:29], v[28:29], v[54:55], v[42:43] op_sel_hi:[1,0,1] neg_lo:[0,0,1] neg_hi:[0,0,1]
    v_pk_fma_f32 v[76:77], v[76:77], v[102:103], v[90:91] op_sel_hi:[1,0,1] neg_lo:[0,0,1] neg_hi:[0,0,1]
    v_pk_fma_f32 v[30:31], v[30:31], v[54:55], v[42:43] op_sel_hi:[1,0,1] neg_lo:[0,0,1] neg_hi:[0,0,1]
    v_pk_fma_f32 v[78:79], v[78:79], v[102:103], v[90:91] op_sel_hi:[1,0,1] neg_lo:[0,0,1] neg_hi:[0,0,1]
    v_pk_fma_f32 v[32:33], v[32:33], v[54:55], v[42:43] op_sel_hi:[1,0,1] neg_lo:[0,0,1] neg_hi:[0,0,1]
    v_pk_fma_f32 v[80:81], v[80:81], v[102:103], v[90:91] op_sel_hi:[1,0,1] neg_lo:[0,0,1] neg_hi:[0,0,1]
    v_cvt_pk_bf16_f32 v44, v24, v25
    v_cvt_pk_bf16_f32 v92, v72, v73
    v_cvt_pk_bf16_f32 v45, v26, v27
    v_cvt_pk_bf16_f32 v93, v74, v75
    v_cvt_pk_bf16_f32 v46, v28, v29
    v_cvt_pk_bf16_f32 v94, v76, v77
    v_cvt_pk_bf16_f32 v47, v30, v31
    v_cvt_pk_bf16_f32 v95, v78, v79
    v_cvt_pk_bf16_f32 v48, v32, v33
    v_cvt_pk_bf16_f32 v96, v80, v81
    ds_write_b128 v60, v[44:47] offset:0
    ds_write_b128 v60, v[92:95] offset:704
    ds_write_b32 v61, v48 offset:0
    ds_write_b32 v61, v96 offset:704
    s_waitcnt lgkmcnt(0)
    v_mov_b32 v12, 47976
    v_mov_b32 v13, 1
    s_mov_b64 exec, 1
    ds_add_u32 v12, v13
    s_mov_b64 exec, -1
    s_add_u32 s6, s7, 0x9E3779B9
    s_branch L_not7
L_pub:
    s_setprio 3
    s_mul_i32 s8, s2, 10240
    s_add_u32 s9, s8, 4096
    s_add_u32 s10, s8, 8192
    ds_read_b64_tr_b16 v[16:17], v4 offset:0
    ds_read_b64_tr_b16 v[18:19], v4 offset:2816
    ds_read_b64_tr_b16 v[20:21], v5 offset:0
    ds_read_b64_tr_b16 v[22:23], v5 offset:2816
    ds_read_b64_tr_b16 v[24:25], v6 offset:0
    ds_read_b64_tr_b16 v[26:27], v6 offset:2816
    ds_read_b64_tr_b16 v[28:29], v7 offset:0
    ds_read_b64_tr_b16 v[30:31], v7 offset:2816
    ds_read_b64_tr_b16 v[32:33], v8 offset:0
    ds_read_b64_tr_b16 v[34:35], v8 offset:2816
    ds_read_b64_tr_b16 v[36:37], v4 offset:28672
    ds_read_b64_tr_b16 v[38:39], v4 offset:31488
    v_and_b32 v100, 16, v2
    ds_read_b128 v[104:107], v100 offset:48032
    s_waitcnt lgkmcnt(11)
    buffer_store_dwordx4 v[16:19], v2, s[52:55], s8 offen offset:0 sc1
    ds_read_b64_tr_b16 v[40:41], v5 offset:28672
    ds_read_b64_tr_b16 v[42:43], v5 offset:31488
    s_waitcnt lgkmcnt(11)
    buffer_store_dwordx4 v[20:23], v2, s[52:55], s8 offen offset:1024 sc1
    ds_read_b64_tr_b16 v[44:45], v6 offset:28672
    ds_read_b64_tr_b16 v[46:47], v6 offset:31488
    s_waitcnt lgkmcnt(11)
    buffer_store_dwordx4 v[24:27], v2, s[52:55], s8 offen offset:2048 sc1
    ds_read_b64_tr_b16 v[48:49], v7 offset:28672
    ds_read_b64_tr_b16 v[50:51], v7 offset:31488
    s_waitcnt lgkmcnt(11)
    buffer_store_dwordx4 v[28:31], v2, s[52:55], s8 offen offset:3072 sc1
    ds_read_b64_tr_b16 v[52:53], v8 offset:28672
    ds_read_b64_tr_b16 v[54:55], v8 offset:31488
    s_waitcnt lgkmcnt(11)
    buffer_store_dwordx4 v[32:35], v2, s[52:55], s9 offen offset:0 sc1
    s_waitcnt lgkmcnt(9)
    buffer_store_dwordx4 v[36:39], v2, s[52:55], s9 offen offset:1024 sc1
    s_waitcnt lgkmcnt(6)
    buffer_store_dwordx4 v[40:43], v2, s[52:55], s9 offen offset:2048 sc1
    s_waitcnt lgkmcnt(4)
    buffer_store_dwordx4 v[44:47], v2, s[52:55], s9 offen offset:3072 sc1
    s_waitcnt lgkmcnt(2)
    buffer_store_dwordx4 v[48:51], v2, s[52:55], s10 offen offset:0 sc1
    s_waitcnt lgkmcnt(0)
    buffer_store_dwordx4 v[52:55], v2, s[52:55], s10 offen offset:1024 sc1
    s_waitcnt lgkmcnt(0)
    v_mov_b32 v12, 47984
    v_mov_b32 v13, 1
    s_mov_b64 exec, 1
    ds_add_u32 v12, v13
    s_mov_b64 exec, -1
    s_lshl_b32 s11, s2, 5
    s_add_u32 s11, s11, 0xa40000
    s_mov_b64 exec, 3
    buffer_store_dwordx4 v[104:107], v2, s[52:55], s11 offen sc1
    s_mov_b64 exec, -1
    s_cmp_ge_u32 s2, 64
    s_cbranch_scc1 L_nozero
    v_mov_b32 v108, 0
    v_mov_b32 v109, 0
    v_mov_b32 v110, 0
    v_mov_b32 v111, 0
    s_lshl_b32 s11, s2, 10
    s_add_u32 s11, s11, 0xa80200
    s_mov_b32 exec_hi, 0
    buffer_store_dwordx4 v[108:111], v2, s[52:55], s11 offen sc1
    s_lshl_b32 s11, s2, 7
    s_add_u32 s11, s11, 0xa10000
    s_mov_b64 exec, 0xff
    buffer_store_dwordx4 v[108:111], v2, s[52:55], s11 offen sc1
    s_mov_b64 exec, -1
L_nozero:
    s_lshl_b32 s11, s2, 7
    s_add_u32 s11, s11, 0xa00000
    s_add_u32 s14, s48, s11
    s_addc_u32 s15, s49, 0
    s_mov_b32 s7, s6
    s_waitcnt vmcnt(0)
    s_atomic_swap s7, s[14:15], 0
    s_waitcnt lgkmcnt(0)
    s_branch L_w7
L_not7:
    s_setprio 3
    s_bfe_u32 s81, s50, 0x40004
    s_mul_i32 s81, s81, 98304
    s_add_u32 s81, s81, s82
    s_add_u32 m0, s80, 4096
    s_nop 0
    buffer_load_dwordx4 v7, s[60:63], s81 offen  lds
    s_add_u32 m0, s80, 5120
    s_add_u32 s8, s81, 49152
    buffer_load_dwordx4 v7, s[60:63], s8 offen  lds
    s_add_u32 m0, s80, 6144
    s_add_u32 s8, s81, 12288
    buffer_load_dwordx4 v7, s[60:63], s8 offen  lds
    s_add_u32 m0, s80, 7168
    s_add_u32 s8, s81, 61440
    buffer_load_dwordx4 v7, s[60:63], s8 offen  lds
    v_lshrrev_b32 v10, 2, v0
    v_bfe_u32 v11, v0, 3, 2
    v_lshlrev_b32 v10, 7, v10
    v_and_b32 v12, 3, v0
    v_lshl_add_u32 v10, v12, 3, v10
    v_add_u32 v10, s80, v10
    v_xor_b32 v12, 0, v11
    v_lshl_add_u32 v2, v12, 5, v10
    v_xor_b32 v12, 1, v11
    v_lshl_add_u32 v3, v12, 5, v10
    v_xor_b32 v12, 2, v11
    v_lshl_add_u32 v4, v12, 5, v10
    v_xor_b32 v12, 3, v11
    v_lshl_add_u32 v5, v12, 5, v10
    v_lshrrev_b32 v10, 4, v0
    v_mul_u32_u24 v10, 10240, v10
    v_and_b32 v11, 15, v0
    v_lshl_add_u32 v6, v11, 4, v10
    s_waitcnt vmcnt(9)
    v_lshrrev_b32 v10, 4, v0
    v_lshlrev_b32 v10, 3, v10
    ds_read_b64 v[80:81], v10 offset:48064
    ds_read_b64 v[82:83], v10 offset:48096
    ds_read_b64 v[84:85], v10 offset:48128
    ds_read_b64 v[86:87], v10 offset:48160
    s_waitcnt lgkmcnt(0)
    v_lshlrev_b32 v16, 16, v80
    v_and_b32 v17, s13, v80
    v_lshlrev_b32 v18, 16, v81
    v_and_b32 v19, s13, v81
    v_lshlrev_b32 v20, 16, v82
    v_and_b32 v21, s13, v82
    v_lshlrev_b32 v22, 16, v83
    v_and_b32 v23, s13, v83
    v_lshlrev_b32 v24, 16, v84
    v_and_b32 v25, s13, v84
    v_lshlrev_b32 v26, 16, v85
    v_and_b32 v27, s13, v85
    v_lshlrev_b32 v28, 16, v86
    v_and_b32 v29, s13, v86
    v_lshlrev_b32 v30, 16, v87
    v_and_b32 v31, s13, v87
    v_mov_b32 v12, 47984
    s_mov_b32 s12, 0x200000
L_lw1:
    ds_read_b32 v13, v12
    s_waitcnt lgkmcnt(0)
    v_readfirstlane_b32 s8, v13
    s_nop 0
    s_cmp_ge_u32 s8, 1
    s_cbranch_scc1 L_lwok1
    s_sub_u32 s12, s12, 1
    s_cmp_lg_u32 s12, 0
    s_cbranch_scc1 L_lw1
L_lwok1:
    s_cmp_ge_u32 s5, 30
    s_cbranch_scc1 L_g2_pre_nog1
    s_mul_i32 s85, s3, 655360
    s_lshl_b32 s8, s76, 10
    s_add_u32 s85, s85, s8
    s_xor_b32 s87, s3, 0
    s_lshl_b32 s87, s87, 8
    s_xor_b32 s88, s3, 1
    s_lshl_b32 s88, s88, 8
    s_xor_b32 s89, s3, 2
    s_lshl_b32 s89, s89, 8
    s_xor_b32 s90, s3, 3
    s_lshl_b32 s90, s90, 8
    s_bfe_u32 s81, s50, 0x40008
    s_mul_i32 s81, s81, 98304
    s_add_u32 s81, s81, s82
    s_add_u32 m0, s80, 8192
    s_nop 0
    buffer_load_dwordx4 v7, s[60:63], s81 offen  lds
    s_add_u32 m0, s80, 9216
    s_add_u32 s8, s81, 49152
    buffer_load_dwordx4 v7, s[60:63], s8 offen  lds
    s_add_u32 m0, s80, 10240
    s_add_u32 s8, s81, 12288
    buffer_load_dwordx4 v7, s[60:63], s8 offen  lds
    s_add_u32 m0, s80, 11264
    s_add_u32 s8, s81, 61440
    buffer_load_dwordx4 v7, s[60:63], s8 offen  lds
    s_waitcnt vmcnt(8)
    ds_read_b64_tr_b16 v[128:129], v2 offset:0
    ds_read_b64_tr_b16 v[130:131], v2 offset:2048
    ds_read_b64_tr_b16 v[132:133], v3 offset:0
    ds_read_b64_tr_b16 v[134:135], v3 offset:2048
    ds_read_b64_tr_b16 v[136:137], v4 offset:0
    ds_read_b64_tr_b16 v[138:139], v4 offset:2048
    ds_read_b64_tr_b16 v[140:141], v5 offset:0
    ds_read_b64_tr_b16 v[142:143], v5 offset:2048
    s_bfe_u32 s81, s50, 0x4000c
    s_mul_i32 s81, s81, 98304
    s_add_u32 s81, s81, s82
    s_add_u32 m0, s80, 12288
    s_nop 0
    buffer_load_dwordx4 v7, s[60:63], s81 offen  lds
    s_add_u32 m0, s80, 13312
    s_add_u32 s8, s81, 49152
    buffer_load_dwordx4 v7, s[60:63], s8 offen  lds
    s_add_u32 m0, s80, 14336
    s_add_u32 s8, s81, 12288
    buffer_load_dwordx4 v7, s[60:63], s8 offen  lds
    s_add_u32 m0, s80, 15360
    s_add_u32 s8, s81, 61440
    buffer_load_dwordx4 v7, s[60:63], s8 offen  lds
    s_waitcnt vmcnt(8)
    ds_read_b64_tr_b16 v[144:145], v2 offset:4096
    ds_read_b64_tr_b16 v[146:147], v2 offset:6144
    ds_read_b64_tr_b16 v[148:149], v3 offset:4096
    ds_read_b64_tr_b16 v[150:151], v3 offset:6144
    ds_read_b64_tr_b16 v[152:153], v4 offset:4096
    ds_read_b64_tr_b16 v[154:155], v4 offset:6144
    ds_read_b64_tr_b16 v[156:157], v5 offset:4096
    ds_read_b64_tr_b16 v[158:159], v5 offset:6144
    s_bfe_u32 s81, s50, 0x40010
    s_mul_i32 s81, s81, 98304
    s_add_u32 s81, s81, s82
    s_add_u32 m0, s80, 16384
    s_nop 0
    buffer_load_dwordx4 v7, s[60:63], s81 offen  lds
    s_add_u32 m0, s80, 17408
    s_add_u32 s8, s81, 49152
    buffer_load_dwordx4 v7, s[60:63], s8 offen  lds
    s_add_u32 m0, s80, 18432
    s_add_u32 s8, s81, 12288
    buffer_load_dwordx4 v7, s[60:63], s8 offen  lds
    s_add_u32 m0, s80, 19456
    s_add_u32 s8, s81, 61440
    buffer_load_dwordx4 v7, s[60:63], s8 offen  lds
    s_waitcnt vmcnt(8)
    ds_read_b64_tr_b16 v[160:161], v2 offset:8192
    ds_read_b64_tr_b16 v[162:163], v2 offset:10240
    ds_read_b64_tr_b16 v[164:165], v3 offset:8192
    ds_read_b64_tr_b16 v[166:167], v3 offset:10240
    ds_read_b64_tr_b16 v[168:169], v4 offset:8192
    ds_read_b64_tr_b16 v[170:171], v4 offset:10240
    ds_read_b64_tr_b16 v[172:173], v5 offset:8192
    ds_read_b64_tr_b16 v[174:175], v5 offset:10240
    s_bfe_u32 s81, s50, 0x40014
    s_mul_i32 s81, s81, 98304
    s_add_u32 s81, s81, s82
    s_add_u32 m0, s80, 20480
    s_nop 0
    buffer_load_dwordx4 v7, s[60:63], s81 offen  lds
    s_add_u32 m0, s80, 21504
    s_add_u32 s8, s81, 49152
    buffer_load_dwordx4 v7, s[60:63], s8 offen  lds
    s_add_u32 m0, s80, 22528
    s_add_u32 s8, s81, 12288
    buffer_load_dwordx4 v7, s[60:63], s8 offen  lds
    s_add_u32 m0, s80, 23552
    s_add_u32 s8, s81, 61440
    buffer_load_dwordx4 v7, s[60:63], s8 offen  lds
    s_waitcnt vmcnt(8)
    ds_read_b64_tr_b16 v[176:177], v2 offset:12288
    ds_read_b64_tr_b16 v[178:179], v2 offset:14336
    ds_read_b64_tr_b16 v[180:181], v3 offset:12288
    ds_read_b64_tr_b16 v[182:183], v3 offset:14336
    ds_read_b64_tr_b16 v[184:185], v4 offset:12288
    ds_read_b64_tr_b16 v[186:187], v4 offset:14336
    ds_read_b64_tr_b16 v[188:189], v5 offset:12288
    ds_read_b64_tr_b16 v[190:191], v5 offset:14336
    s_bfe_u32 s81, s50, 0x40018
    s_mul_i32 s81, s81, 98304
    s_add_u32 s81, s81, s82
    s_add_u32 m0, s80, 24576
    s_nop 0
    buffer_load_dwordx4 v7, s[60:63], s81 offen  lds
    s_add_u32 m0, s80, 25600
    s_add_u32 s8, s81, 49152
    buffer_load_dwordx4 v7, s[60:63], s8 offen  lds
    s_add_u32 m0, s80, 26624
    s_add_u32 s8, s81, 12288
    buffer_load_dwordx4 v7, s[60:63], s8 offen  lds
    s_add_u32 m0, s80, 27648
    s_add_u32 s8, s81, 61440
    buffer_load_dwordx4 v7, s[60:63], s8 offen  lds
    s_waitcnt vmcnt(8)
    ds_read_b64_tr_b16 v[192:193], v2 offset:16384
    ds_read_b64_tr_b16 v[194:195], v2 offset:18432
    ds_read_b64_tr_b16 v[196:197], v3 offset:16384
    ds_read_b64_tr_b16 v[198:199], v3 offset:18432
    ds_read_b64_tr_b16 v[200:201], v4 offset:16384
    ds_read_b64_tr_b16 v[202:203], v4 offset:18432
    ds_read_b64_tr_b16 v[204:205], v5 offset:16384
    ds_read_b64_tr_b16 v[206:207], v5 offset:18432
    s_waitcnt lgkmcnt(15)
    s_bfe_u32 s81, s50, 0x4001c
    s_mul_i32 s81, s81, 98304
    s_add_u32 s81, s81, s82
    s_add_u32 m0, s80, 0
    s_nop 0
    buffer_load_dwordx4 v7, s[60:63], s81 offen  lds
    s_add_u32 m0, s80, 1024
    s_add_u32 s8, s81, 49152
    buffer_load_dwordx4 v7, s[60:63], s8 offen  lds
    s_add_u32 m0, s80, 2048
    s_add_u32 s8, s81, 12288
    buffer_load_dwordx4 v7, s[60:63], s8 offen  lds
    s_add_u32 m0, s80, 3072
    s_add_u32 s8, s81, 61440
    buffer_load_dwordx4 v7, s[60:63], s8 offen  lds
    s_waitcnt vmcnt(8)
    ds_read_b64_tr_b16 v[208:209], v2 offset:20480
    ds_read_b64_tr_b16 v[210:211], v2 offset:22528
    ds_read_b64_tr_b16 v[212:213], v3 offset:20480
    ds_read_b64_tr_b16 v[214:215], v3 offset:22528
    ds_read_b64_tr_b16 v[216:217], v4 offset:20480
    ds_read_b64_tr_b16 v[218:219], v4 offset:22528
    ds_read_b64_tr_b16 v[220:221], v5 offset:20480
    ds_read_b64_tr_b16 v[222:223], v5 offset:22528
    s_bfe_u32 s81, s51, 0x40000
    s_mul_i32 s81, s81, 98304
    s_add_u32 s81, s81, s82
    s_add_u32 m0, s80, 4096
    s_nop 0
    buffer_load_dwordx4 v7, s[60:63], s81 offen  lds
    s_add_u32 m0, s80, 5120
    s_add_u32 s8, s81, 49152
    buffer_load_dwordx4 v7, s[60:63], s8 offen  lds
    s_add_u32 m0, s80, 6144
    s_add_u32 s8, s81, 12288
    buffer_load_dwordx4 v7, s[60:63], s8 offen  lds
    s_add_u32 m0, s80, 7168
    s_add_u32 s8, s81, 61440
    buffer_load_dwordx4 v7, s[60:63], s8 offen  lds
    s_waitcnt vmcnt(8)
    ds_read_b64_tr_b16 v[224:225], v2 offset:24576
    ds_read_b64_tr_b16 v[226:227], v2 offset:26624
    ds_read_b64_tr_b16 v[228:229], v3 offset:24576
    ds_read_b64_tr_b16 v[230:231], v3 offset:26624
    ds_read_b64_tr_b16 v[232:233], v4 offset:24576
    ds_read_b64_tr_b16 v[234:235], v4 offset:26624
    ds_read_b64_tr_b16 v[236:237], v5 offset:24576
    ds_read_b64_tr_b16 v[238:239], v5 offset:26624
    s_bfe_u32 s81, s51, 0x40004
    s_mul_i32 s81, s81, 98304
    s_add_u32 s81, s81, s82
    s_add_u32 m0, s80, 8192
    s_nop 0
    buffer_load_dwordx4 v7, s[60:63], s81 offen  lds
    s_add_u32 m0, s80, 9216
    s_add_u32 s8, s81, 49152
    buffer_load_dwordx4 v7, s[60:63], s8 offen  lds
    s_add_u32 m0, s80, 10240
    s_add_u32 s8, s81, 12288
    buffer_load_dwordx4 v7, s[60:63], s8 offen  lds
    s_add_u32 m0, s80, 11264
    s_add_u32 s8, s81, 61440
    buffer_load_dwordx4 v7, s[60:63], s8 offen  lds
    s_waitcnt vmcnt(8)
    ds_read_b64_tr_b16 v[240:241], v2 offset:0
    ds_read_b64_tr_b16 v[242:243], v2 offset:2048
    ds_read_b64_tr_b16 v[244:245], v3 offset:0
    ds_read_b64_tr_b16 v[246:247], v3 offset:2048
    ds_read_b64_tr_b16 v[248:249], v4 offset:0
    ds_read_b64_tr_b16 v[250:251], v4 offset:2048
    ds_read_b64_tr_b16 v[252:253], v5 offset:0
    ds_read_b64_tr_b16 v[254:255], v5 offset:2048
    s_waitcnt lgkmcnt(15)
    s_bfe_u32 s81, s51, 0x40008
    s_mul_i32 s81, s81, 98304
    s_add_u32 s81, s81, s82
    s_add_u32 m0, s80, 12288
    s_nop 0
    buffer_load_dwordx4 v7, s[60:63], s81 offen  lds
    s_add_u32 m0, s80, 13312
    s_add_u32 s8, s81, 49152
    buffer_load_dwordx4 v7, s[60:63], s8 offen  lds
    s_add_u32 m0, s80, 14336
    s_add_u32 s8, s81, 12288
    buffer_load_dwordx4 v7, s[60:63], s8 offen  lds
    s_add_u32 m0, s80, 15360
    s_add_u32 s8, s81, 61440
    buffer_load_dwordx4 v7, s[60:63], s8 offen  lds
    s_waitcnt vmcnt(8)
    s_bfe_u32 s81, s51, 0x4000c
    s_mul_i32 s81, s81, 98304
    s_add_u32 s81, s81, s82
    s_add_u32 m0, s80, 16384
    s_nop 0
    buffer_load_dwordx4 v7, s[60:63], s81 offen  lds
    s_add_u32 m0, s80, 17408
    s_add_u32 s8, s81, 49152
    buffer_load_dwordx4 v7, s[60:63], s8 offen  lds
    s_add_u32 m0, s80, 18432
    s_add_u32 s8, s81, 12288
    buffer_load_dwordx4 v7, s[60:63], s8 offen  lds
    s_add_u32 m0, s80, 19456
    s_add_u32 s8, s81, 61440
    buffer_load_dwordx4 v7, s[60:63], s8 offen  lds
    s_waitcnt vmcnt(8)
    s_bfe_u32 s81, s51, 0x40010
    s_mul_i32 s81, s81, 98304
    s_add_u32 s81, s81, s82
    s_add_u32 m0, s80, 20480
    s_nop 0
    buffer_load_dwordx4 v7, s[60:63], s81 offen  lds
    s_add_u32 m0, s80, 21504
    s_add_u32 s8, s81, 49152
    buffer_load_dwordx4 v7, s[60:63], s8 offen  lds
    s_add_u32 m0, s80, 22528
    s_add_u32 s8, s81, 12288
    buffer_load_dwordx4 v7, s[60:63], s8 offen  lds
    s_add_u32 m0, s80, 23552
    s_add_u32 s8, s81, 61440
    buffer_load_dwordx4 v7, s[60:63], s8 offen  lds
    s_waitcnt vmcnt(8)
    s_waitcnt lgkmcnt(8)
    s_waitcnt lgkmcnt(0)
    s_lshl_b32 s9, s2, 3
    s_add_u32 s9, s9, s3
    s_lshl_b32 s9, s9, 7
    s_add_u32 s9, s9, 0xa80000
    s_add_u32 s14, s48, s9
    s_addc_u32 s15, s49, 0
    s_load_dword s7, s[14:15], 0 glc
    s_bfe_u32 s81, s51, 0x40014
    s_mul_i32 s81, s81, 98304
    s_add_u32 s81, s81, s82
    s_add_u32 m0, s80, 24576
    s_nop 0
    buffer_load_dwordx4 v7, s[60:63], s81 offen  lds
    s_add_u32 m0, s80, 25600
    s_add_u32 s8, s81, 49152
    buffer_load_dwordx4 v7, s[60:63], s8 offen  lds
    s_add_u32 m0, s80, 26624
    s_add_u32 s8, s81, 12288
    buffer_load_dwordx4 v7, s[60:63], s8 offen  lds
    s_add_u32 m0, s80, 27648
    s_add_u32 s8, s81, 61440
    buffer_load_dwordx4 v7, s[60:63], s8 offen  lds
    s_waitcnt vmcnt(8)
    s_bfe_u32 s81, s51, 0x40018
    s_mul_i32 s81, s81, 98304
    s_add_u32 s81, s81, s82
    s_add_u32 m0, s80, 0
    s_nop 0
    buffer_load_dwordx4 v7, s[60:63], s81 offen  lds
    s_add_u32 m0, s80, 1024
    s_add_u32 s8, s81, 49152
    buffer_load_dwordx4 v7, s[60:63], s8 offen  lds
    s_add_u32 m0, s80, 2048
    s_add_u32 s8, s81, 12288
    buffer_load_dwordx4 v7, s[60:63], s8 offen  lds
    s_add_u32 m0, s80, 3072
    s_add_u32 s8, s81, 61440
    buffer_load_dwordx4 v7, s[60:63], s8 offen  lds
    s_mov_b32 s12, 65536
    s_branch L_sq0
L_sp0:
    s_load_dword s7, s[14:15], 0 glc
L_sq0:
    s_waitcnt lgkmcnt(0)
    s_cmp_eq_u32 s7, s6
    s_cbranch_scc1 L_spok0
    s_sub_u32 s12, s12, 1
    s_cmp_lg_u32 s12, 0
    s_cbranch_scc1 L_sp0
L_spok0:
    s_setprio 2
    s_bfe_u32 s84, s50, 0x40000
    s_mul_i32 s84, s84, 40960
    s_add_u32 s84, s84, s85
    s_add_u32 s9, s84, s87
    buffer_load_dwordx4 v[80:83], v6, s[52:55], s9 offen sc1
    s_add_u32 s9, s84, s88
    buffer_load_dwordx4 v[84:87], v6, s[52:55], s9 offen sc1
    s_add_u32 s9, s84, s89
    buffer_load_dwordx4 v[88:91], v6, s[52:55], s9 offen sc1
    s_add_u32 s9, s84, s90
    buffer_load_dwordx4 v[92:95], v6, s[52:55], s9 offen sc1
    s_bfe_u32 s84, s50, 0x40004
    s_mul_i32 s84, s84, 40960
    s_add_u32 s84, s84, s85
    s_add_u32 s9, s84, s87
    buffer_load_dwordx4 v[96:99], v6, s[52:55], s9 offen sc1
    s_add_u32 s9, s84, s88
    buffer_load_dwordx4 v[100:103], v6, s[52:55], s9 offen sc1
    s_add_u32 s9, s84, s89
    buffer_load_dwordx4 v[104:107], v6, s[52:55], s9 offen sc1
    s_add_u32 s9, s84, s90
    buffer_load_dwordx4 v[108:111], v6, s[52:55], s9 offen sc1
    s_bfe_u32 s84, s50, 0x40008
    s_mul_i32 s84, s84, 40960
    s_add_u32 s84, s84, s85
    s_add_u32 s9, s84, s87
    buffer_load_dwordx4 v[112:115], v6, s[52:55], s9 offen sc1
    s_add_u32 s9, s84, s88
    buffer_load_dwordx4 v[116:119], v6, s[52:55], s9 offen sc1
    s_add_u32 s9, s84, s89
    buffer_load_dwordx4 v[120:123], v6, s[52:55], s9 offen sc1
    s_add_u32 s9, s84, s90
    buffer_load_dwordx4 v[124:127], v6, s[52:55], s9 offen sc1
    v_mov_b32 v12, 47980
    v_mov_b32 v13, 1
    s_mov_b64 exec, 1
    ds_add_u32 v12, v13
    s_mov_b64 exec, -1
    s_waitcnt vmcnt(11)
    v_mfma_f32_16x16x32_bf16 v[16:19], v[128:131], v[80:83], v[16:19]
    s_bfe_u32 s84, s50, 0x4000c
    v_mfma_f32_16x16x32_bf16 v[20:23], v[132:135], v[80:83], v[20:23]
    s_mul_i32 s84, s84, 40960
    v_mfma_f32_16x16x32_bf16 v[24:27], v[136:139], v[80:83], v[24:27]
    s_add_u32 s84, s84, s85
    v_mfma_f32_16x16x32_bf16 v[28:31], v[140:143], v[80:83], v[28:31]
    s_add_u32 s9, s84, s87
    buffer_load_dwordx4 v[80:83], v6, s[52:55], s9 offen sc1
    s_waitcnt vmcnt(11)
    v_mfma_f32_16x16x32_bf16 v[32:35], v[128:131], v[84:87], 0
    s_add_u32 s9, s84, s88
    v_mfma_f32_16x16x32_bf16 v[36:39], v[132:135], v[84:87], 0
    v_mfma_f32_16x16x32_bf16 v[40:43], v[136:139], v[84:87], 0
    v_mfma_f32_16x16x32_bf16 v[44:47], v[140:143], v[84:87], 0
    buffer_load_dwordx4 v[84:87], v6, s[52:55], s9 offen sc1
    s_waitcnt vmcnt(11)
    v_mfma_f32_16x16x32_bf16 v[48:51], v[128:131], v[88:91], 0
    s_add_u32 s9, s84, s89
    v_mfma_f32_16x16x32_bf16 v[52:55], v[132:135], v[88:91], 0
    v_mfma_f32_16x16x32_bf16 v[56:59], v[136:139], v[88:91], 0
    v_mfma_f32_16x16x32_bf16 v[60:63], v[140:143], v[88:91], 0
    buffer_load_dwordx4 v[88:91], v6, s[52:55], s9 offen sc1
    s_waitcnt vmcnt(11)
    v_mfma_f32_16x16x32_bf16 v[64:67], v[128:131], v[92:95], 0
    s_add_u32 s9, s84, s90
    v_mfma_f32_16x16x32_bf16 v[68:71], v[132:135], v[92:95], 0
    v_mfma_f32_16x16x32_bf16 v[72:75], v[136:139], v[92:95], 0
    v_mfma_f32_16x16x32_bf16 v[76:79], v[140:143], v[92:95], 0
    buffer_load_dwordx4 v[92:95], v6, s[52:55], s9 offen sc1
    s_waitcnt vmcnt(11)
    v_mfma_f32_16x16x32_bf16 v[16:19], v[144:147], v[96:99], v[16:19]
    s_bfe_u32 s84, s50, 0x40010
    v_mfma_f32_16x16x32_bf16 v[20:23], v[148:151], v[96:99], v[20:23]
    s_mul_i32 s84, s84, 40960
    v_mfma_f32_16x16x32_bf16 v[24:27], v[152:155], v[96:99], v[24:27]
    s_add_u32 s84, s84, s85
    v_mfma_f32_16x16x32_bf16 v[28:31], v[156:159], v[96:99], v[28:31]
    s_add_u32 s9, s84, s87
    buffer_load_dwordx4 v[96:99], v6, s[52:55], s9 offen sc1
    s_waitcnt vmcnt(11)
    v_mfma_f32_16x16x32_bf16 v[32:35], v[144:147], v[100:103], v[32:35]
    s_add_u32 s9, s84, s88
    v_mfma_f32_16x16x32_bf16 v[36:39], v[148:151], v[100:103], v[36:39]
    v_mfma_f32_16x16x32_bf16 v[40:43], v[152:155], v[100:103], v[40:43]
    ds_read_b64_tr_b16 v[128:129], v2 offset:4096
    v_mfma_f32_16x16x32_bf16 v[44:47], v[156:159], v[100:103], v[44:47]
    buffer_load_dwordx4 v[100:103], v6, s[52:55], s9 offen sc1
    s_waitcnt vmcnt(11)
    v_mfma_f32_16x16x32_bf16 v[48:51], v[144:147], v[104:107], v[48:51]
    s_add_u32 s9, s84, s89
    v_mfma_f32_16x16x32_bf16 v[52:55], v[148:151], v[104:107], v[52:55]
    ds_read_b64_tr_b16 v[130:131], v2 offset:6144
    v_mfma_f32_16x16x32_bf16 v[56:59], v[152:155], v[104:107], v[56:59]
    ds_read_b64_tr_b16 v[132:133], v3 offset:4096
    v_mfma_f32_16x16x32_bf16 v[60:63], v[156:159], v[104:107], v[60:63]
    buffer_load_dwordx4 v[104:107], v6, s[52:55], s9 offen sc1
    s_waitcnt vmcnt(11)
    v_mfma_f32_16x16x32_bf16 v[64:67], v[144:147], v[108:111], v[64:67]
    s_add_u32 s9, s84, s90
    v_mfma_f32_16x16x32_bf16 v[68:71], v[148:151], v[108:111], v[68:71]
    ds_read_b64_tr_b16 v[134:135], v3 offset:6144
    v_mfma_f32_16x16x32_bf16 v[72:75], v[152:155], v[108:111], v[72:75]
    ds_read_b64_tr_b16 v[136:137], v4 offset:4096
    v_mfma_f32_16x16x32_bf16 v[76:79], v[156:159], v[108:111], v[76:79]
    buffer_load_dwordx4 v[108:111], v6, s[52:55], s9 offen sc1
    s_waitcnt vmcnt(11)
    v_mfma_f32_16x16x32_bf16 v[16:19], v[160:163], v[112:115], v[16:19]
    s_bfe_u32 s84, s50, 0x40014
    v_mfma_f32_16x16x32_bf16 v[20:23], v[164:167], v[112:115], v[20:23]
    s_mul_i32 s84, s84, 40960
    v_mfma_f32_16x16x32_bf16 v[24:27], v[168:171], v[112:115], v[24:27]
    s_add_u32 s84, s84, s85
    v_mfma_f32_16x16x32_bf16 v[28:31], v[172:175], v[112:115], v[28:31]
    s_add_u32 s9, s84, s87
    buffer_load_dwordx4 v[112:115], v6, s[52:55], s9 offen sc1
    s_waitcnt vmcnt(11)
    v_mfma_f32_16x16x32_bf16 v[32:35], v[160:163], v[116:119], v[32:35]
    s_add_u32 s9, s84, s88
    v_mfma_f32_16x16x32_bf16 v[36:39], v[164:167], v[116:119], v[36:39]
    ds_read_b64_tr_b16 v[138:139], v4 offset:6144
    v_mfma_f32_16x16x32_bf16 v[40:43], v[168:171], v[116:119], v[40:43]
    ds_read_b64_tr_b16 v[140:141], v5 offset:4096
    v_mfma_f32_16x16x32_bf16 v[44:47], v[172:175], v[116:119], v[44:47]
    buffer_load_dwordx4 v[116:119], v6, s[52:55], s9 offen sc1
    s_waitcnt vmcnt(11)
    v_mfma_f32_16x16x32_bf16 v[48:51], v[160:163], v[120:123], v[48:51]
    s_add_u32 s9, s84, s89
    v_mfma_f32_16x16x32_bf16 v[52:55], v[164:167], v[120:123], v[52:55]
    ds_read_b64_tr_b16 v[142:143], v5 offset:6144
    v_mfma_f32_16x16x32_bf16 v[56:59], v[168:171], v[120:123], v[56:59]
    v_mfma_f32_16x16x32_bf16 v[60:63], v[172:175], v[120:123], v[60:63]
    buffer_load_dwordx4 v[120:123], v6, s[52:55], s9 offen sc1
    s_waitcnt vmcnt(11)
    v_mfma_f32_16x16x32_bf16 v[64:67], v[160:163], v[124:127], v[64:67]
    s_add_u32 s9, s84, s90
    v_mfma_f32_16x16x32_bf16 v[68:71], v[164:167], v[124:127], v[68:71]
    ds_read_b64_tr_b16 v[144:145], v2 offset:8192
    v_mfma_f32_16x16x32_bf16 v[72:75], v[168:171], v[124:127], v[72:75]
    ds_read_b64_tr_b16 v[146:147], v2 offset:10240
    v_mfma_f32_16x16x32_bf16 v[76:79], v[172:175], v[124:127], v[76:79]
    buffer_load_dwordx4 v[124:127], v6, s[52:55], s9 offen sc1
    s_waitcnt vmcnt(11)
    v_mfma_f32_16x16x32_bf16 v[16:19], v[176:179], v[80:83], v[16:19]
    s_bfe_u32 s84, s50, 0x40018
    v_mfma_f32_16x16x32_bf16 v[20:23], v[180:183], v[80:83], v[20:23]
    s_mul_i32 s84, s84, 40960
    v_mfma_f32_16x16x32_bf16 v[24:27], v[184:187], v[80:83], v[24:27]
    s_add_u32 s84, s84, s85
    v_mfma_f32_16x16x32_bf16 v[28:31], v[188:191], v[80:83], v[28:31]
    s_add_u32 s9, s84, s87
    buffer_load_dwordx4 v[80:83], v6, s[52:55], s9 offen sc1
    s_waitcnt vmcnt(11)
    v_mfma_f32_16x16x32_bf16 v[32:35], v[176:179], v[84:87], v[32:35]
    s_add_u32 s9, s84, s88
    v_mfma_f32_16x16x32_bf16 v[36:39], v[180:183], v[84:87], v[36:39]
    ds_read_b64_tr_b16 v[148:149], v3 offset:8192
    v_mfma_f32_16x16x32_bf16 v[40:43], v[184:187], v[84:87], v[40:43]
    ds_read_b64_tr_b16 v[150:151], v3 offset:10240
    v_mfma_f32_16x16x32_bf16 v[44:47], v[188:191], v[84:87], v[44:47]
    buffer_load_dwordx4 v[84:87], v6, s[52:55], s9 offen sc1
    s_waitcnt vmcnt(11)
    v_mfma_f32_16x16x32_bf16 v[48:51], v[176:179], v[88:91], v[48:51]
    s_add_u32 s9, s84, s89
    v_mfma_f32_16x16x32_bf16 v[52:55], v[180:183], v[88:91], v[52:55]
    ds_read_b64_tr_b16 v[152:153], v4 offset:8192
    v_mfma_f32_16x16x32_bf16 v[56:59], v[184:187], v[88:91], v[56:59]
    ds_read_b64_tr_b16 v[154:155], v4 offset:10240
    v_mfma_f32_16x16x32_bf16 v[60:63], v[188:191], v[88:91], v[60:63]
    buffer_load_dwordx4 v[88:91], v6, s[52:55], s9 offen sc1
    s_waitcnt vmcnt(11)
    v_mfma_f32_16x16x32_bf16 v[64:67], v[176:179], v[92:95], v[64:67]
    s_add_u32 s9, s84, s90
    v_mfma_f32_16x16x32_bf16 v[68:71], v[180:183], v[92:95], v[68:71]
    ds_read_b64_tr_b16 v[156:157], v5 offset:8192
    v_mfma_f32_16x16x32_bf16 v[72:75], v[184:187], v[92:95], v[72:75]
    ds_read_b64_tr_b16 v[158:159], v5 offset:10240
    v_mfma_f32_16x16x32_bf16 v[76:79], v[188:191], v[92:95], v[76:79]
    buffer_load_dwordx4 v[92:95], v6, s[52:55], s9 offen sc1
    s_waitcnt vmcnt(11)
    v_mfma_f32_16x16x32_bf16 v[16:19], v[192:195], v[96:99], v[16:19]
    s_bfe_u32 s84, s50, 0x4001c
    v_mfma_f32_16x16x32_bf16 v[20:23], v[196:199], v[96:99], v[20:23]
    s_mul_i32 s84, s84, 40960
    v_mfma_f32_16x16x32_bf16 v[24:27], v[200:203], v[96:99], v[24:27]
    s_add_u32 s84, s84, s85
    v_mfma_f32_16x16x32_bf16 v[28:31], v[204:207], v[96:99], v[28:31]
    s_add_u32 s9, s84, s87
    buffer_load_dwordx4 v[96:99], v6, s[52:55], s9 offen sc1
    s_waitcnt vmcnt(11)
    v_mfma_f32_16x16x32_bf16 v[32:35], v[192:195], v[100:103], v[32:35]
    s_add_u32 s9, s84, s88
    v_mfma_f32_16x16x32_bf16 v[36:39], v[196:199], v[100:103], v[36:39]
    s_waitcnt lgkmcnt(8)
    v_mfma_f32_16x16x32_bf16 v[40:43], v[200:203], v[100:103], v[40:43]
    s_bfe_u32 s81, s51, 0x4001c
    v_mfma_f32_16x16x32_bf16 v[44:47], v[204:207], v[100:103], v[44:47]
    buffer_load_dwordx4 v[100:103], v6, s[52:55], s9 offen sc1
    s_waitcnt vmcnt(11)
    v_mfma_f32_16x16x32_bf16 v[48:51], v[192:195], v[104:107], v[48:51]
    s_add_u32 s9, s84, s89
    v_mfma_f32_16x16x32_bf16 v[52:55], v[196:199], v[104:107], v[52:55]
    s_mul_i32 s81, s81, 98304
    v_mfma_f32_16x16x32_bf16 v[56:59], v[200:203], v[104:107], v[56:59]
    s_add_u32 s81, s81, s82
    v_mfma_f32_16x16x32_bf16 v[60:63], v[204:207], v[104:107], v[60:63]
    buffer_load_dwordx4 v[104:107], v6, s[52:55], s9 offen sc1
    s_waitcnt vmcnt(11)
    v_mfma_f32_16x16x32_bf16 v[64:67], v[192:195], v[108:111], v[64:67]
    s_add_u32 s9, s84, s90
    v_mfma_f32_16x16x32_bf16 v[68:71], v[196:199], v[108:111], v[68:71]
    s_add_u32 m0, s80, 4096
    v_mfma_f32_16x16x32_bf16 v[72:75], v[200:203], v[108:111], v[72:75]
    buffer_load_dwordx4 v7, s[60:63], s81 offen  lds
    v_mfma_f32_16x16x32_bf16 v[76:79], v[204:207], v[108:111], v[76:79]
    buffer_load_dwordx4 v[108:111], v6, s[52:55], s9 offen sc1
    s_waitcnt vmcnt(12)
    v_mfma_f32_16x16x32_bf16 v[16:19], v[208:211], v[112:115], v[16:19]
    s_bfe_u32 s84, s51, 0x40000
    v_mfma_f32_16x16x32_bf16 v[20:23], v[212:215], v[112:115], v[20:23]
    s_mul_i32 s84, s84, 40960
    v_mfma_f32_16x16x32_bf16 v[24:27], v[216:219], v[112:115], v[24:27]
    s_add_u32 s84, s84, s85
    v_mfma_f32_16x16x32_bf16 v[28:31], v[220:223], v[112:115], v[28:31]
    s_add_u32 s9, s84, s87
    buffer_load_dwordx4 v[112:115], v6, s[52:55], s9 offen sc1
    s_waitcnt vmcnt(12)
    v_mfma_f32_16x16x32_bf16 v[32:35], v[208:211], v[116:119], v[32:35]
    s_add_u32 s9, s84, s88
    v_mfma_f32_16x16x32_bf16 v[36:39], v[212:215], v[116:119], v[36:39]
    s_add_u32 m0, s80, 5120
    v_mfma_f32_16x16x32_bf16 v[40:43], v[216:219], v[116:119], v[40:43]
    s_add_u32 s8, s81, 49152
    v_mfma_f32_16x16x32_bf16 v[44:47], v[220:223], v[116:119], v[44:47]
    buffer_load_dwordx4 v[116:119], v6, s[52:55], s9 offen sc1
    s_waitcnt vmcnt(12)
    v_mfma_f32_16x16x32_bf16 v[48:51], v[208:211], v[120:123], v[48:51]
    s_add_u32 s9, s84, s89
    v_mfma_f32_16x16x32_bf16 v[52:55], v[212:215], v[120:123], v[52:55]
    buffer_load_dwordx4 v7, s[60:63], s8 offen  lds
    v_mfma_f32_16x16x32_bf16 v[56:59], v[216:219], v[120:123], v[56:59]
    s_add_u32 m0, s80, 6144
    v_mfma_f32_16x16x32_bf16 v[60:63], v[220:223], v[120:123], v[60:63]
    buffer_load_dwordx4 v[120:123], v6, s[52:55], s9 offen sc1
    s_waitcnt vmcnt(13)
    v_mfma_f32_16x16x32_bf16 v[64:67], v[208:211], v[124:127], v[64:67]
    s_add_u32 s9, s84, s90
    v_mfma_f32_16x16x32_bf16 v[68:71], v[212:215], v[124:127], v[68:71]
    s_add_u32 s8, s81, 12288
    v_mfma_f32_16x16x32_bf16 v[72:75], v[216:219], v[124:127], v[72:75]
    buffer_load_dwordx4 v7, s[60:63], s8 offen  lds
    v_mfma_f32_16x16x32_bf16 v[76:79], v[220:223], v[124:127], v[76:79]
    buffer_load_dwordx4 v[124:127], v6, s[52:55], s9 offen sc1
    s_waitcnt vmcnt(14)
    v_mfma_f32_16x16x32_bf16 v[16:19], v[224:227], v[80:83], v[16:19]
    s_bfe_u32 s84, s51, 0x40004
    v_mfma_f32_16x16x32_bf16 v[20:23], v[228:231], v[80:83], v[20:23]
    s_mul_i32 s84, s84, 40960
    v_mfma_f32_16x16x32_bf16 v[24:27], v[232:235], v[80:83], v[24:27]
    s_add_u32 s84, s84, s85
    v_mfma_f32_16x16x32_bf16 v[28:31], v[236:239], v[80:83], v[28:31]
    s_add_u32 s9, s84, s87
    buffer_load_dwordx4 v[80:83], v6, s[52:55], s9 offen sc1
    s_waitcnt vmcnt(14)
    v_mfma_f32_16x16x32_bf16 v[32:35], v[224:227], v[84:87], v[32:35]
    s_add_u32 s9, s84, s88
    v_mfma_f32_16x16x32_bf16 v[36:39], v[228:231], v[84:87], v[36:39]
    s_add_u32 m0, s80, 7168
    v_mfma_f32_16x16x32_bf16 v[40:43], v[232:235], v[84:87], v[40:43]
    s_add_u32 s8, s81, 61440
    v_mfma_f32_16x16x32_bf16 v[44:47], v[236:239], v[84:87], v[44:47]
    buffer_load_dwordx4 v[84:87], v6, s[52:55], s9 offen sc1
    s_waitcnt vmcnt(14)
    v_mfma_f32_16x16x32_bf16 v[48:51], v[224:227], v[88:91], v[48:51]
    s_add_u32 s9, s84, s89
    v_mfma_f32_16x16x32_bf16 v[52:55], v[228:231], v[88:91], v[52:55]
    buffer_load_dwordx4 v7, s[60:63], s8 offen  lds
    v_mfma_f32_16x16x32_bf16 v[56:59], v[232:235], v[88:91], v[56:59]
    v_lshrrev_b32 v10, 3, v0
    v_mfma_f32_16x16x32_bf16 v[60:63], v[236:239], v[88:91], v[60:63]
    buffer_load_dwordx4 v[88:91], v6, s[52:55], s9 offen sc1
    s_waitcnt vmcnt(15)
    v_mfma_f32_16x16x32_bf16 v[64:67], v[224:227], v[92:95], v[64:67]
    s_add_u32 s9, s84, s90
    v_mfma_f32_16x16x32_bf16 v[68:71], v[228:231], v[92:95], v[68:71]
    v_and_b32 v11, 6, v10
    v_mfma_f32_16x16x32_bf16 v[72:75], v[232:235], v[92:95], v[72:75]
    v_and_b32 v12, 7, v0
    v_mfma_f32_16x16x32_bf16 v[76:79], v[236:239], v[92:95], v[76:79]
    buffer_load_dwordx4 v[92:95], v6, s[52:55], s9 offen sc1
    s_waitcnt vmcnt(15)
    v_mfma_f32_16x16x32_bf16 v[16:19], v[240:243], v[96:99], v[16:19]
    s_bfe_u32 s84, s51, 0x40008
    v_mfma_f32_16x16x32_bf16 v[20:23], v[244:247], v[96:99], v[20:23]
    s_mul_i32 s84, s84, 40960
    v_mfma_f32_16x16x32_bf16 v[24:27], v[248:251], v[96:99], v[24:27]
    s_add_u32 s84, s84, s85
    v_mfma_f32_16x16x32_bf16 v[28:31], v[252:255], v[96:99], v[28:31]
    s_add_u32 s9, s84, s87
    buffer_load_dwordx4 v[96:99], v6, s[52:55], s9 offen sc1
    s_waitcnt vmcnt(15)
    v_mfma_f32_16x16x32_bf16 v[32:35], v[240:243], v[100:103], v[32:35]
    s_add_u32 s9, s84, s88
    v_mfma_f32_16x16x32_bf16 v[36:39], v[244:247], v[100:103], v[36:39]
    v_xor_b32 v12, v12, v11
    v_mfma_f32_16x16x32_bf16 v[40:43], v[248:251], v[100:103], v[40:43]
    v_lshlrev_b32 v12, 4, v12
    v_mfma_f32_16x16x32_bf16 v[44:47], v[252:255], v[100:103], v[44:47]
    buffer_load_dwordx4 v[100:103], v6, s[52:55], s9 offen sc1
    s_waitcnt vmcnt(15)
    v_mfma_f32_16x16x32_bf16 v[48:51], v[240:243], v[104:107], v[48:51]
    s_add_u32 s9, s84, s89
    v_mfma_f32_16x16x32_bf16 v[52:55], v[244:247], v[104:107], v[52:55]
    s_mov_b32 s8, 4096
    v_mfma_f32_16x16x32_bf16 v[56:59], v[248:251], v[104:107], v[56:59]
    v_mul_lo_u32 v10, v10, s8
    v_mfma_f32_16x16x32_bf16 v[60:63], v[252:255], v[104:107], v[60:63]
    buffer_load_dwordx4 v[104:107], v6, s[52:55], s9 offen sc1
    s_waitcnt vmcnt(14)
    v_mfma_f32_16x16x32_bf16 v[64:67], v[240:243], v[108:111], v[64:67]
    s_add_u32 s9, s84, s90
    v_mfma_f32_16x16x32_bf16 v[68:71], v[244:247], v[108:111], v[68:71]
    v_add_u32 v7, v10, v12
    v_mfma_f32_16x16x32_bf16 v[72:75], v[248:251], v[108:111], v[72:75]
    s_mul_i32 s82, s3, 1572864
    v_mfma_f32_16x16x32_bf16 v[76:79], v[252:255], v[108:111], v[76:79]
    buffer_load_dwordx4 v[108:111], v6, s[52:55], s9 offen sc1
    s_waitcnt vmcnt(14)
    v_mfma_f32_16x16x32_bf16 v[16:19], v[128:131], v[112:115], v[16:19]
    s_bfe_u32 s84, s51, 0x4000c
    v_mfma_f32_16x16x32_bf16 v[20:23], v[132:135], v[112:115], v[20:23]
    s_mul_i32 s84, s84, 40960
    v_mfma_f32_16x16x32_bf16 v[24:27], v[136:139], v[112:115], v[24:27]
    s_add_u32 s84, s84, s85
    v_mfma_f32_16x16x32_bf16 v[28:31], v[140:143], v[112:115], v[28:31]
    s_add_u32 s9, s84, s87
    buffer_load_dwordx4 v[112:115], v6, s[52:55], s9 offen sc1
    s_waitcnt vmcnt(14)
    v_mfma_f32_16x16x32_bf16 v[32:35], v[128:131], v[116:119], v[32:35]
    s_add_u32 s9, s84, s88
    v_mfma_f32_16x16x32_bf16 v[36:39], v[132:135], v[116:119], v[36:39]
    s_lshl_b32 s8, s79, 7
    v_mfma_f32_16x16x32_bf16 v[40:43], v[136:139], v[116:119], v[40:43]
    s_add_u32 s82, s82, s8
    v_mfma_f32_16x16x32_bf16 v[44:47], v[140:143], v[116:119], v[44:47]
    buffer_load_dwordx4 v[116:119], v6, s[52:55], s9 offen sc1
    s_waitcnt vmcnt(13)
    v_mfma_f32_16x16x32_bf16 v[48:51], v[128:131], v[120:123], v[48:51]
    s_add_u32 s9, s84, s89
    v_mfma_f32_16x16x32_bf16 v[52:55], v[132:135], v[120:123], v[52:55]
    v_mfma_f32_16x16x32_bf16 v[56:59], v[136:139], v[120:123], v[56:59]
    ds_read_b64_tr_b16 v[160:161], v2 offset:12288
    v_mfma_f32_16x16x32_bf16 v[60:63], v[140:143], v[120:123], v[60:63]
    buffer_load_dwordx4 v[120:123], v6, s[52:55], s9 offen sc1
    s_waitcnt vmcnt(12)
    v_mfma_f32_16x16x32_bf16 v[64:67], v[128:131], v[124:127], v[64:67]
    s_add_u32 s9, s84, s90
    v_mfma_f32_16x16x32_bf16 v[68:71], v[132:135], v[124:127], v[68:71]
    ds_read_b64_tr_b16 v[162:163], v2 offset:14336
    v_mfma_f32_16x16x32_bf16 v[72:75], v[136:139], v[124:127], v[72:75]
    ds_read_b64_tr_b16 v[164:165], v3 offset:12288
    v_mfma_f32_16x16x32_bf16 v[76:79], v[140:143], v[124:127], v[76:79]
    buffer_load_dwordx4 v[124:127], v6, s[52:55], s9 offen sc1
    s_waitcnt lgkmcnt(3)
    s_waitcnt vmcnt(12)
    v_mfma_f32_16x16x32_bf16 v[16:19], v[144:147], v[80:83], v[16:19]
    s_bfe_u32 s84, s51, 0x40010
    v_mfma_f32_16x16x32_bf16 v[20:23], v[148:151], v[80:83], v[20:23]
    s_mul_i32 s84, s84, 40960
    v_mfma_f32_16x16x32_bf16 v[24:27], v[152:155], v[80:83], v[24:27]
    s_add_u32 s84, s84, s85
    v_mfma_f32_16x16x32_bf16 v[28:31], v[156:159], v[80:83], v[28:31]
    s_add_u32 s9, s84, s87
    buffer_load_dwordx4 v[80:83], v6, s[52:55], s9 offen sc1
    s_waitcnt vmcnt(12)
    v_mfma_f32_16x16x32_bf16 v[32:35], v[144:147], v[84:87], v[32:35]
    s_add_u32 s9, s84, s88
    v_mfma_f32_16x16x32_bf16 v[36:39], v[148:151], v[84:87], v[36:39]
    ds_read_b64_tr_b16 v[166:167], v3 offset:14336
    v_mfma_f32_16x16x32_bf16 v[40:43], v[152:155], v[84:87], v[40:43]
    ds_read_b64_tr_b16 v[168:169], v4 offset:12288
    v_mfma_f32_16x16x32_bf16 v[44:47], v[156:159], v[84:87], v[44:47]
    buffer_load_dwordx4 v[84:87], v6, s[52:55], s9 offen sc1
    s_waitcnt vmcnt(11)
    v_mfma_f32_16x16x32_bf16 v[48:51], v[144:147], v[88:91], v[48:51]
    s_add_u32 s9, s84, s89
    v_mfma_f32_16x16x32_bf16 v[52:55], v[148:151], v[88:91], v[52:55]
    ds_read_b64_tr_b16 v[170:171], v4 offset:14336
    v_mfma_f32_16x16x32_bf16 v[56:59], v[152:155], v[88:91], v[56:59]
    ds_read_b64_tr_b16 v[172:173], v5 offset:12288
    v_mfma_f32_16x16x32_bf16 v[60:63], v[156:159], v[88:91], v[60:63]
    buffer_load_dwordx4 v[88:91], v6, s[52:55], s9 offen sc1
    s_waitcnt vmcnt(11)
    v_mfma_f32_16x16x32_bf16 v[64:67], v[144:147], v[92:95], v[64:67]
    s_add_u32 s9, s84, s90
    v_mfma_f32_16x16x32_bf16 v[68:71], v[148:151], v[92:95], v[68:71]
    ds_read_b64_tr_b16 v[174:175], v5 offset:14336
    v_mfma_f32_16x16x32_bf16 v[72:75], v[152:155], v[92:95], v[72:75]
    v_mfma_f32_16x16x32_bf16 v[76:79], v[156:159], v[92:95], v[76:79]
    buffer_load_dwordx4 v[92:95], v6, s[52:55], s9 offen sc1
    s_waitcnt lgkmcnt(0)
    s_waitcnt vmcnt(11)
    v_mfma_f32_16x16x32_bf16 v[16:19], v[160:163], v[96:99], v[16:19]
    s_bfe_u32 s84, s51, 0x40014
    v_mfma_f32_16x16x32_bf16 v[20:23], v[164:167], v[96:99], v[20:23]
    s_mul_i32 s84, s84, 40960
    v_mfma_f32_16x16x32_bf16 v[24:27], v[168:171], v[96:99], v[24:27]
    s_add_u32 s84, s84, s85
    v_mfma_f32_16x16x32_bf16 v[28:31], v[172:175], v[96:99], v[28:31]
    s_add_u32 s9, s84, s87
    buffer_load_dwordx4 v[96:99], v6, s[52:55], s9 offen sc1
    s_waitcnt vmcnt(11)
    v_mfma_f32_16x16x32_bf16 v[32:35], v[160:163], v[100:103], v[32:35]
    s_add_u32 s9, s84, s88
    v_mfma_f32_16x16x32_bf16 v[36:39], v[164:167], v[100:103], v[36:39]
    ds_read_b64_tr_b16 v[176:177], v2 offset:16384
    v_mfma_f32_16x16x32_bf16 v[40:43], v[168:171], v[100:103], v[40:43]
    ds_read_b64_tr_b16 v[178:179], v2 offset:18432
    v_mfma_f32_16x16x32_bf16 v[44:47], v[172:175], v[100:103], v[44:47]
    buffer_load_dwordx4 v[100:103], v6, s[52:55], s9 offen sc1
    s_waitcnt vmcnt(11)
    v_mfma_f32_16x16x32_bf16 v[48:51], v[160:163], v[104:107], v[48:51]
    s_add_u32 s9, s84, s89
    v_mfma_f32_16x16x32_bf16 v[52:55], v[164:167], v[104:107], v[52:55]
    ds_read_b64_tr_b16 v[180:181], v3 offset:16384
    v_mfma_f32_16x16x32_bf16 v[56:59], v[168:171], v[104:107], v[56:59]
    ds_read_b64_tr_b16 v[182:183], v3 offset:18432
    v_mfma_f32_16x16x32_bf16 v[60:63], v[172:175], v[104:107], v[60:63]
    buffer_load_dwordx4 v[104:107], v6, s[52:55], s9 offen sc1
    s_waitcnt vmcnt(11)
    v_mfma_f32_16x16x32_bf16 v[64:67], v[160:163], v[108:111], v[64:67]
    s_add_u32 s9, s84, s90
    v_mfma_f32_16x16x32_bf16 v[68:71], v[164:167], v[108:111], v[68:71]
    ds_read_b64_tr_b16 v[184:185], v4 offset:16384
    v_mfma_f32_16x16x32_bf16 v[72:75], v[168:171], v[108:111], v[72:75]
    ds_read_b64_tr_b16 v[186:187], v4 offset:18432
    v_mfma_f32_16x16x32_bf16 v[76:79], v[172:175], v[108:111], v[76:79]
    buffer_load_dwordx4 v[108:111], v6, s[52:55], s9 offen sc1
    ds_read_b64_tr_b16 v[188:189], v5 offset:16384
    ds_read_b64_tr_b16 v[190:191], v5 offset:18432
    s_waitcnt lgkmcnt(0)
    s_waitcnt vmcnt(11)
    v_mfma_f32_16x16x32_bf16 v[16:19], v[176:179], v[112:115], v[16:19]
    s_bfe_u32 s84, s51, 0x40018
    v_mfma_f32_16x16x32_bf16 v[20:23], v[180:183], v[112:115], v[20:23]
    s_mul_i32 s84, s84, 40960
    v_mfma_f32_16x16x32_bf16 v[24:27], v[184:187], v[112:115], v[24:27]
    s_add_u32 s84, s84, s85
    v_mfma_f32_16x16x32_bf16 v[28:31], v[188:191], v[112:115], v[28:31]
    s_add_u32 s9, s84, s87
    buffer_load_dwordx4 v[112:115], v6, s[52:55], s9 offen sc1
    s_waitcnt vmcnt(11)
    v_mfma_f32_16x16x32_bf16 v[32:35], v[176:179], v[116:119], v[32:35]
    s_add_u32 s9, s84, s88
    v_mfma_f32_16x16x32_bf16 v[36:39], v[180:183], v[116:119], v[36:39]
    v_mfma_f32_16x16x32_bf16 v[40:43], v[184:187], v[116:119], v[40:43]
    ds_read_b64_tr_b16 v[192:193], v2 offset:20480
    v_mfma_f32_16x16x32_bf16 v[44:47], v[188:191], v[116:119], v[44:47]
    buffer_load_dwordx4 v[116:119], v6, s[52:55], s9 offen sc1
    s_waitcnt vmcnt(11)
    v_mfma_f32_16x16x32_bf16 v[48:51], v[176:179], v[120:123], v[48:51]
    s_add_u32 s9, s84, s89
    v_mfma_f32_16x16x32_bf16 v[52:55], v[180:183], v[120:123], v[52:55]
    ds_read_b64_tr_b16 v[194:195], v2 offset:22528
    v_mfma_f32_16x16x32_bf16 v[56:59], v[184:187], v[120:123], v[56:59]
    ds_read_b64_tr_b16 v[196:197], v3 offset:20480
    v_mfma_f32_16x16x32_bf16 v[60:63], v[188:191], v[120:123], v[60:63]
    buffer_load_dwordx4 v[120:123], v6, s[52:55], s9 offen sc1
    s_waitcnt vmcnt(11)
    v_mfma_f32_16x16x32_bf16 v[64:67], v[176:179], v[124:127], v[64:67]
    s_add_u32 s9, s84, s90
    v_mfma_f32_16x16x32_bf16 v[68:71], v[180:183], v[124:127], v[68:71]
    ds_read_b64_tr_b16 v[198:199], v3 offset:22528
    v_mfma_f32_16x16x32_bf16 v[72:75], v[184:187], v[124:127], v[72:75]
    ds_read_b64_tr_b16 v[200:201], v4 offset:20480
    v_mfma_f32_16x16x32_bf16 v[76:79], v[188:191], v[124:127], v[76:79]
    buffer_load_dwordx4 v[124:127], v6, s[52:55], s9 offen sc1
    ds_read_b64_tr_b16 v[202:203], v4 offset:22528
    ds_read_b64_tr_b16 v[204:205], v5 offset:20480
    ds_read_b64_tr_b16 v[206:207], v5 offset:22528
    s_waitcnt lgkmcnt(0)
    s_waitcnt vmcnt(11)
    v_mfma_f32_16x16x32_bf16 v[16:19], v[192:195], v[80:83], v[16:19]
    s_bfe_u32 s84, s51, 0x4001c
    v_mfma_f32_16x16x32_bf16 v[20:23], v[196:199], v[80:83], v[20:23]
    s_mul_i32 s84, s84, 40960
    v_mfma_f32_16x16x32_bf16 v[24:27], v[200:203], v[80:83], v[24:27]
    s_add_u32 s84, s84, s85
    v_mfma_f32_16x16x32_bf16 v[28:31], v[204:207], v[80:83], v[28:31]
    s_add_u32 s9, s84, s88
    buffer_load_dwordx4 v[80:83], v6, s[52:55], s9 offen sc1
    s_waitcnt vmcnt(11)
    v_mfma_f32_16x16x32_bf16 v[32:35], v[192:195], v[84:87], v[32:35]
    s_add_u32 s9, s84, s89
    v_mfma_f32_16x16x32_bf16 v[36:39], v[196:199], v[84:87], v[36:39]
    v_mfma_f32_16x16x32_bf16 v[40:43], v[200:203], v[84:87], v[40:43]
    ds_read_b64_tr_b16 v[208:209], v2 offset:24576
    v_mfma_f32_16x16x32_bf16 v[44:47], v[204:207], v[84:87], v[44:47]
    buffer_load_dwordx4 v[84:87], v6, s[52:55], s9 offen sc1
    s_waitcnt vmcnt(11)
    v_mfma_f32_16x16x32_bf16 v[48:51], v[192:195], v[88:91], v[48:51]
    s_add_u32 s9, s84, s90
    v_mfma_f32_16x16x32_bf16 v[52:55], v[196:199], v[88:91], v[52:55]
    ds_read_b64_tr_b16 v[210:211], v2 offset:26624
    v_mfma_f32_16x16x32_bf16 v[56:59], v[200:203], v[88:91], v[56:59]
    ds_read_b64_tr_b16 v[212:213], v3 offset:24576
    v_mfma_f32_16x16x32_bf16 v[60:63], v[204:207], v[88:91], v[60:63]
    buffer_load_dwordx4 v[88:91], v6, s[52:55], s9 offen sc1
    s_waitcnt vmcnt(11)
    v_mfma_f32_16x16x32_bf16 v[64:67], v[192:195], v[92:95], v[64:67]
    s_add_u32 s9, s84, s87
    v_mfma_f32_16x16x32_bf16 v[68:71], v[196:199], v[92:95], v[68:71]
    ds_read_b64_tr_b16 v[214:215], v3 offset:26624
    v_mfma_f32_16x16x32_bf16 v[72:75], v[200:203], v[92:95], v[72:75]
    ds_read_b64_tr_b16 v[216:217], v4 offset:24576
    v_mfma_f32_16x16x32_bf16 v[76:79], v[204:207], v[92:95], v[76:79]
    buffer_load_dwordx4 v[92:95], v6, s[52:55], s9 offen sc1
    ds_read_b64_tr_b16 v[218:219], v4 offset:26624
    ds_read_b64_tr_b16 v[220:221], v5 offset:24576
    ds_read_b64_tr_b16 v[222:223], v5 offset:26624
    s_waitcnt lgkmcnt(0)
    s_waitcnt vmcnt(11)
    v_mfma_f32_16x16x32_bf16 v[16:19], v[208:211], v[96:99], v[16:19]
    v_mfma_f32_16x16x32_bf16 v[20:23], v[212:215], v[96:99], v[20:23]
    ds_read_b64_tr_b16 v[224:225], v2 offset:0
    v_mfma_f32_16x16x32_bf16 v[24:27], v[216:219], v[96:99], v[24:27]
    ds_read_b64_tr_b16 v[226:227], v2 offset:2048
    v_mfma_f32_16x16x32_bf16 v[28:31], v[220:223], v[96:99], v[28:31]
    ds_read_b64_tr_b16 v[228:229], v3 offset:0
    s_waitcnt vmcnt(10)
    v_mfma_f32_16x16x32_bf16 v[32:35], v[208:211], v[100:103], v[32:35]
    ds_read_b64_tr_b16 v[230:231], v3 offset:2048
    v_mfma_f32_16x16x32_bf16 v[36:39], v[212:215], v[100:103], v[36:39]
    ds_read_b64_tr_b16 v[232:233], v4 offset:0
    v_mfma_f32_16x16x32_bf16 v[40:43], v[216:219], v[100:103], v[40:43]
    ds_read_b64_tr_b16 v[234:235], v4 offset:2048
    v_mfma_f32_16x16x32_bf16 v[44:47], v[220:223], v[100:103], v[44:47]
    ds_read_b64_tr_b16 v[236:237], v5 offset:0
    s_waitcnt vmcnt(9)
    v_mfma_f32_16x16x32_bf16 v[48:51], v[208:211], v[104:107], v[48:51]
    ds_read_b64_tr_b16 v[238:239], v5 offset:2048
    v_mfma_f32_16x16x32_bf16 v[52:55], v[212:215], v[104:107], v[52:55]
    v_mfma_f32_16x16x32_bf16 v[56:59], v[216:219], v[104:107], v[56:59]
    ds_read_b64_tr_b16 v[240:241], v2 offset:4096
    v_mfma_f32_16x16x32_bf16 v[60:63], v[220:223], v[104:107], v[60:63]
    ds_read_b64_tr_b16 v[242:243], v2 offset:6144
    s_waitcnt vmcnt(8)
    v_mfma_f32_16x16x32_bf16 v[64:67], v[208:211], v[108:111], v[64:67]
    ds_read_b64_tr_b16 v[244:245], v3 offset:4096
    v_mfma_f32_16x16x32_bf16 v[68:71], v[212:215], v[108:111], v[68:71]
    ds_read_b64_tr_b16 v[246:247], v3 offset:6144
    v_mfma_f32_16x16x32_bf16 v[72:75], v[216:219], v[108:111], v[72:75]
    ds_read_b64_tr_b16 v[248:249], v4 offset:4096
    v_mfma_f32_16x16x32_bf16 v[76:79], v[220:223], v[108:111], v[76:79]
    ds_read_b64_tr_b16 v[250:251], v4 offset:6144
    ds_read_b64_tr_b16 v[252:253], v5 offset:4096
    ds_read_b64_tr_b16 v[254:255], v5 offset:6144
    s_lshl_b32 s8, s3, 5
    v_xor_b32 v2, s8, v2
    v_xor_b32 v3, s8, v3
    v_xor_b32 v4, s8, v4
    v_xor_b32 v5, s8, v5
    v_lshlrev_b32 v10, 4, v0
    v_add_u32 v128, s80, v10
    s_xor_b32 s8, s3, 1
    s_mul_i32 s8, s8, 28672
    s_add_u32 s8, s8, 49152
    v_add_u32 v129, s8, v10
    s_xor_b32 s8, s3, 2
    s_mul_i32 s8, s8, 28672
    s_add_u32 s8, s8, 49152
    v_add_u32 v130, s8, v10
    s_xor_b32 s8, s3, 3
    s_mul_i32 s8, s8, 28672
    s_add_u32 s8, s8, 49152
    v_add_u32 v131, s8, v10
    v_mov_b32 v132, 0xbdd2d3e8
    v_mov_b32 v133, 0xbdd2d3e8
    v_mov_b32 v134, 0xc0135761
    v_mov_b32 v135, 0xc0135761
    v_and_b32 v12, 15, v0
    v_lshrrev_b32 v13, 4, v0
    v_mul_u32_u24 v9, 1280, v12
    v_lshl_add_u32 v1, v13, 3, v9
    v_lshl_add_u32 v9, v13, 4, v9
    s_lshl_b32 s10, s79, 2
    s_add_u32 s10, s10, s3
    s_mul_i32 s97, s10, 20480
    s_mul_i32 s11, s78, 160
    s_add_u32 s97, s97, s11
    s_mul_i32 s83, s77, 81920
    s_lshl_b32 s10, s76, 10
    s_add_u32 s83, s83, s10
    s_add_u32 s83, s83, s87
    s_add_u32 s83, s83, 0x500000
    s_add_u32 s96, s83, 40960
    s_lshl_b32 s10, s76, 2
    s_add_u32 s10, s10, s3
    s_mul_i32 s10, s10, 52
    s_lshr_b32 s10, s10, 8
    s_mul_i32 s86, s77, 43
    s_lshr_b32 s86, s86, 8
    s_lshl_b32 s86, s86, 7
    s_add_u32 s86, s86, 0xa80200
    s_lshl_b32 s10, s10, 13
    s_add_u32 s86, s86, s10
    s_waitcnt lgkmcnt(8)
    s_waitcnt vmcnt(7)
    v_mfma_f32_16x16x32_bf16 v[16:19], v[224:227], v[112:115], v[16:19]
    s_bfe_u32 s81, s91, 0x40000
    v_mfma_f32_16x16x32_bf16 v[20:23], v[228:231], v[112:115], v[20:23]
    s_mul_i32 s81, s81, 131072
    v_mfma_f32_16x16x32_bf16 v[24:27], v[232:235], v[112:115], v[24:27]
    s_add_u32 s81, s81, s82
    v_mfma_f32_16x16x32_bf16 v[28:31], v[236:239], v[112:115], v[28:31]
    s_add_u32 m0, s80, 12288
    s_waitcnt vmcnt(6)
    v_mfma_f32_16x16x32_bf16 v[32:35], v[224:227], v[116:119], v[32:35]
    buffer_load_dwordx4 v7, s[64:67], s81 offen  lds
    v_mfma_f32_16x16x32_bf16 v[36:39], v[228:231], v[116:119], v[36:39]
    s_add_u32 m0, s80, 13312
    v_mfma_f32_16x16x32_bf16 v[40:43], v[232:235], v[116:119], v[40:43]
    s_add_u32 s8, s81, 32768
    v_mfma_f32_16x16x32_bf16 v[44:47], v[236:239], v[116:119], v[44:47]
    buffer_load_dwordx4 v7, s[64:67], s8 offen  lds
    s_waitcnt vmcnt(7)
    v_mfma_f32_16x16x32_bf16 v[48:51], v[224:227], v[120:123], v[48:51]
    s_add_u32 m0, s80, 14336
    v_mfma_f32_16x16x32_bf16 v[52:55], v[228:231], v[120:123], v[52:55]
    s_add_u32 s8, s81, 65536
    v_mfma_f32_16x16x32_bf16 v[56:59], v[232:235], v[120:123], v[56:59]
    buffer_load_dwordx4 v7, s[64:67], s8 offen  lds
    v_mfma_f32_16x16x32_bf16 v[60:63], v[236:239], v[120:123], v[60:63]
    s_add_u32 m0, s80, 15360
    s_waitcnt vmcnt(7)
    v_mfma_f32_16x16x32_bf16 v[64:67], v[224:227], v[124:127], v[64:67]
    s_add_u32 s8, s81, 98304
    v_mfma_f32_16x16x32_bf16 v[68:71], v[228:231], v[124:127], v[68:71]
    buffer_load_dwordx4 v7, s[64:67], s8 offen  lds
    v_mfma_f32_16x16x32_bf16 v[72:75], v[232:235], v[124:127], v[72:75]
    s_bfe_u32 s81, s91, 0x40004
    v_mfma_f32_16x16x32_bf16 v[76:79], v[236:239], v[124:127], v[76:79]
    s_mul_i32 s81, s81, 131072
    s_waitcnt lgkmcnt(0)
    s_waitcnt vmcnt(7)
    v_mfma_f32_16x16x32_bf16 v[32:35], v[240:243], v[80:83], v[32:35]
    s_add_u32 s81, s81, s82
    v_mfma_f32_16x16x32_bf16 v[36:39], v[244:247], v[80:83], v[36:39]
    s_add_u32 m0, s80, 16384
    v_mfma_f32_16x16x32_bf16 v[40:43], v[248:251], v[80:83], v[40:43]
    buffer_load_dwordx4 v7, s[64:67], s81 offen  lds
    v_mfma_f32_16x16x32_bf16 v[44:47], v[252:255], v[80:83], v[44:47]
    s_add_u32 m0, s80, 17408
    s_waitcnt vmcnt(7)
    v_mfma_f32_16x16x32_bf16 v[48:51], v[240:243], v[84:87], v[48:51]
    s_add_u32 s8, s81, 32768
    v_mfma_f32_16x16x32_bf16 v[52:55], v[244:247], v[84:87], v[52:55]
    buffer_load_dwordx4 v7, s[64:67], s8 offen  lds
    v_mfma_f32_16x16x32_bf16 v[56:59], v[248:251], v[84:87], v[56:59]
    s_add_u32 m0, s80, 18432
    v_mfma_f32_16x16x32_bf16 v[60:63], v[252:255], v[84:87], v[60:63]
    s_add_u32 s8, s81, 65536
    ds_write_b128 v128, v[32:35] offset:0
    ds_write_b128 v128, v[36:39] offset:1024
    ds_write_b128 v128, v[40:43] offset:2048
    ds_write_b128 v128, v[44:47] offset:3072
    s_waitcnt vmcnt(7)
    v_mfma_f32_16x16x32_bf16 v[64:67], v[240:243], v[88:91], v[64:67]
    buffer_load_dwordx4 v7, s[64:67], s8 offen  lds
    v_mfma_f32_16x16x32_bf16 v[68:71], v[244:247], v[88:91], v[68:71]
    s_add_u32 m0, s80, 19456
    v_mfma_f32_16x16x32_bf16 v[72:75], v[248:251], v[88:91], v[72:75]
    s_add_u32 s8, s81, 98304
    v_mfma_f32_16x16x32_bf16 v[76:79], v[252:255], v[88:91], v[76:79]
    buffer_load_dwordx4 v7, s[64:67], s8 offen  lds
    ds_write_b128 v128, v[48:51] offset:4096
    ds_write_b128 v128, v[52:55] offset:5120
    ds_write_b128 v128, v[56:59] offset:6144
    ds_write_b128 v128, v[60:63] offset:7168
    s_waitcnt vmcnt(8)
    v_mfma_f32_16x16x32_bf16 v[16:19], v[240:243], v[92:95], v[16:19]
    v_mfma_f32_16x16x32_bf16 v[20:23], v[244:247], v[92:95], v[20:23]
    v_mfma_f32_16x16x32_bf16 v[24:27], v[248:251], v[92:95], v[24:27]
    v_mfma_f32_16x16x32_bf16 v[28:31], v[252:255], v[92:95], v[28:31]
    ds_write_b128 v128, v[64:67] offset:8192
    ds_write_b128 v128, v[68:71] offset:9216
    ds_write_b128 v128, v[72:75] offset:10240
    ds_write_b128 v128, v[76:79] offset:11264
    s_setprio 3
    s_waitcnt lgkmcnt(0)
    v_mov_b32 v12, 47968
    v_mov_b32 v13, 1
    s_mov_b64 exec, 1
    ds_add_u32 v12, v13
    s_mov_b64 exec, -1
    v_mov_b32 v12, 47968
    s_mov_b32 s12, 0x200000
L_lw2:
    ds_read_b32 v13, v12
    s_waitcnt lgkmcnt(0)
    v_readfirstlane_b32 s8, v13
    s_nop 0
    s_cmp_ge_u32 s8, 4
    s_cbranch_scc1 L_lwok2
    s_sub_u32 s12, s12, 1
    s_cmp_lg_u32 s12, 0
    s_cbranch_scc1 L_lw2
L_lwok2:
L_ep1:
    ds_read_b128 v[32:35], v129 offset:0
    ds_read_b128 v[48:51], v130 offset:4096
    ds_read_b128 v[64:67], v131 offset:8192
    ds_read_b128 v[36:39], v129 offset:1024
    ds_read_b128 v[52:55], v130 offset:5120
    ds_read_b128 v[68:71], v131 offset:9216
    ds_read_b128 v[40:43], v129 offset:2048
    ds_read_b128 v[56:59], v130 offset:6144
    ds_read_b128 v[72:75], v131 offset:10240
    ds_read_b128 v[44:47], v129 offset:3072
    ds_read_b128 v[60:63], v130 offset:7168
    ds_read_b128 v[76:79], v131 offset:11264
    s_bfe_u32 s81, s91, 0x40008
    s_mul_i32 s81, s81, 131072
    s_add_u32 s81, s81, s82
    s_add_u32 m0, s80, 20480
    s_nop 0
    buffer_load_dwordx4 v7, s[64:67], s81 offen  lds
    s_add_u32 m0, s80, 21504
    s_add_u32 s8, s81, 32768
    buffer_load_dwordx4 v7, s[64:67], s8 offen  lds
    s_add_u32 m0, s80, 22528
    s_add_u32 s8, s81, 65536
    buffer_load_dwordx4 v7, s[64:67], s8 offen  lds
    s_add_u32 m0, s80, 23552
    s_add_u32 s8, s81, 98304
    buffer_load_dwordx4 v7, s[64:67], s8 offen  lds
    s_bfe_u32 s81, s91, 0x4000c
    s_mul_i32 s81, s81, 131072
    s_add_u32 s81, s81, s82
    s_add_u32 m0, s80, 24576
    s_nop 0
    buffer_load_dwordx4 v7, s[64:67], s81 offen  lds
    s_add_u32 m0, s80, 25600
    s_add_u32 s8, s81, 32768
    buffer_load_dwordx4 v7, s[64:67], s8 offen  lds
    s_add_u32 m0, s80, 26624
    s_add_u32 s8, s81, 65536
    buffer_load_dwordx4 v7, s[64:67], s8 offen  lds
    s_add_u32 m0, s80, 27648
    s_add_u32 s8, s81, 98304
    buffer_load_dwordx4 v7, s[64:67], s8 offen  lds
    s_waitcnt lgkmcnt(6)
    v_pk_add_f32 v[16:17], v[16:17], v[32:33]
    v_pk_add_f32 v[18:19], v[18:19], v[34:35]
    v_pk_add_f32 v[20:21], v[20:21], v[36:37]
    v_pk_add_f32 v[22:23], v[22:23], v[38:39]
    v_pk_add_f32 v[48:49], v[48:49], v[64:65]
    v_pk_add_f32 v[50:51], v[50:51], v[66:67]
    v_pk_add_f32 v[52:53], v[52:53], v[68:69]
    v_pk_add_f32 v[54:55], v[54:55], v[70:71]
    v_pk_add_f32 v[16:17], v[16:17], v[48:49]
    v_pk_add_f32 v[18:19], v[18:19], v[50:51]
    v_pk_add_f32 v[20:21], v[20:21], v[52:53]
    v_pk_add_f32 v[22:23], v[22:23], v[54:55]
    v_pk_mul_f32 v[32:33], v[16:17], v[16:17]
    v_pk_mul_f32 v[34:35], v[18:19], v[18:19]
    v_pk_mul_f32 v[36:37], v[20:21], v[20:21]
    v_pk_mul_f32 v[38:39], v[22:23], v[22:23]
    v_pk_fma_f32 v[32:33], v[32:33], v[132:133], v[134:135]
    v_pk_fma_f32 v[34:35], v[34:35], v[132:133], v[134:135]
    v_pk_fma_f32 v[36:37], v[36:37], v[132:133], v[134:135]
    v_pk_fma_f32 v[38:39], v[38:39], v[132:133], v[134:135]
    v_pk_mul_f32 v[32:33], v[32:33], v[16:17]
    v_pk_mul_f32 v[34:35], v[34:35], v[18:19]
    v_pk_mul_f32 v[36:37], v[36:37], v[20:21]
    v_pk_mul_f32 v[38:39], v[38:39], v[22:23]
    v_exp_f32 v32, v32
    v_exp_f32 v33, v33
    v_exp_f32 v34, v34
    v_exp_f32 v35, v35
    v_exp_f32 v36, v36
    v_exp_f32 v37, v37
    v_exp_f32 v38, v38
    v_exp_f32 v39, v39
    v_pk_add_f32 v[32:33], v[32:33], 1.0 op_sel_hi:[1,0]
    v_pk_add_f32 v[34:35], v[34:35], 1.0 op_sel_hi:[1,0]
    v_pk_add_f32 v[36:37], v[36:37], 1.0 op_sel_hi:[1,0]
    v_pk_add_f32 v[38:39], v[38:39], 1.0 op_sel_hi:[1,0]
    v_rcp_f32 v32, v32
    v_rcp_f32 v33, v33
    v_rcp_f32 v34, v34
    v_rcp_f32 v35, v35
    v_rcp_f32 v36, v36
    v_rcp_f32 v37, v37
    v_rcp_f32 v38, v38
    v_rcp_f32 v39, v39
    v_pk_mul_f32 v[32:33], v[32:33], v[16:17]
    v_pk_mul_f32 v[34:35], v[34:35], v[18:19]
    v_pk_mul_f32 v[36:37], v[36:37], v[20:21]
    v_pk_mul_f32 v[38:39], v[38:39], v[22:23]
    v_cvt_pk_bf16_f32 v80, v32, v33
    v_cvt_pk_bf16_f32 v81, v34, v35
    v_cvt_pk_bf16_f32 v82, v36, v37
    v_cvt_pk_bf16_f32 v83, v38, v39
    buffer_store_dwordx4 v[80:83], v6, s[52:55], s83 offen sc1
    s_waitcnt lgkmcnt(0)
    v_mov_b32 v12, 47972
    v_mov_b32 v13, 1
    s_mov_b64 exec, 1
    ds_add_u32 v12, v13
    s_mov_b64 exec, -1
    v_pk_add_f32 v[24:25], v[24:25], v[40:41]
    v_pk_add_f32 v[26:27], v[26:27], v[42:43]
    v_pk_add_f32 v[28:29], v[28:29], v[44:45]
    v_pk_add_f32 v[30:31], v[30:31], v[46:47]
    v_pk_add_f32 v[56:57], v[56:57], v[72:73]
    v_pk_add_f32 v[58:59], v[58:59], v[74:75]
    v_pk_add_f32 v[60:61], v[60:61], v[76:77]
    v_pk_add_f32 v[62:63], v[62:63], v[78:79]
    v_pk_add_f32 v[24:25], v[24:25], v[56:57]
    v_pk_add_f32 v[26:27], v[26:27], v[58:59]
    v_pk_add_f32 v[28:29], v[28:29], v[60:61]
    v_pk_add_f32 v[30:31], v[30:31], v[62:63]
    v_pk_mul_f32 v[40:41], v[24:25], v[24:25]
    v_pk_mul_f32 v[42:43], v[26:27], v[26:27]
    v_pk_mul_f32 v[44:45], v[28:29], v[28:29]
    v_pk_mul_f32 v[46:47], v[30:31], v[30:31]
    v_pk_fma_f32 v[40:41], v[40:41], v[132:133], v[134:135]
    v_pk_fma_f32 v[42:43], v[42:43], v[132:133], v[134:135]
    v_pk_fma_f32 v[44:45], v[44:45], v[132:133], v[134:135]
    v_pk_fma_f32 v[46:47], v[46:47], v[132:133], v[134:135]
    v_pk_mul_f32 v[40:41], v[40:41], v[24:25]
    v_pk_mul_f32 v[42:43], v[42:43], v[26:27]
    v_pk_mul_f32 v[44:45], v[44:45], v[28:29]
    v_pk_mul_f32 v[46:47], v[46:47], v[30:31]
    v_exp_f32 v40, v40
    v_exp_f32 v41, v41
    v_exp_f32 v42, v42
    v_exp_f32 v43, v43
    v_exp_f32 v44, v44
    v_exp_f32 v45, v45
    v_exp_f32 v46, v46
    v_exp_f32 v47, v47
    v_pk_add_f32 v[40:41], v[40:41], 1.0 op_sel_hi:[1,0]
    v_pk_add_f32 v[42:43], v[42:43], 1.0 op_sel_hi:[1,0]
    v_pk_add_f32 v[44:45], v[44:45], 1.0 op_sel_hi:[1,0]
    v_pk_add_f32 v[46:47], v[46:47], 1.0 op_sel_hi:[1,0]
    v_rcp_f32 v40, v40
    v_rcp_f32 v41, v41
    v_rcp_f32 v42, v42
    v_rcp_f32 v43, v43
    v_rcp_f32 v44, v44
    v_rcp_f32 v45, v45
    v_rcp_f32 v46, v46
    v_rcp_f32 v47, v47
    v_pk_mul_f32 v[40:41], v[40:41], v[24:25]
    v_pk_mul_f32 v[42:43], v[42:43], v[26:27]
    v_pk_mul_f32 v[44:45], v[44:45], v[28:29]
    v_pk_mul_f32 v[46:47], v[46:47], v[30:31]
    v_cvt_pk_bf16_f32 v84, v40, v41
    v_cvt_pk_bf16_f32 v85, v42, v43
    v_cvt_pk_bf16_f32 v86, v44, v45
    v_cvt_pk_bf16_f32 v87, v46, v47
    buffer_store_dwordx4 v[84:87], v6, s[52:55], s96 offen sc1
    v_mov_b32 v12, 47996
    v_mov_b32 v13, 1
    s_mov_b64 exec, 1
    ds_add_u32 v12, v13
    s_mov_b64 exec, -1
    v_mov_b32 v12, 47972
    s_mov_b32 s12, 0x200000
L_lw3:
    ds_read_b32 v13, v12
    s_waitcnt lgkmcnt(0)
    v_readfirstlane_b32 s8, v13
    s_nop 0
    s_cmp_ge_u32 s8, 4
    s_cbranch_scc1 L_lwok3
    s_sub_u32 s12, s12, 1
    s_cmp_lg_u32 s12, 0
    s_cbranch_scc1 L_lw3
L_lwok3:
    s_bfe_u32 s81, s91, 0x40010
    s_mul_i32 s81, s81, 131072
    s_add_u32 s81, s81, s82
    s_add_u32 m0, s80, 0
    s_nop 0
    buffer_load_dwordx4 v7, s[64:67], s81 offen  lds
    s_add_u32 m0, s80, 1024
    s_add_u32 s8, s81, 32768
    buffer_load_dwordx4 v7, s[64:67], s8 offen  lds
    s_add_u32 m0, s80, 2048
    s_add_u32 s8, s81, 65536
    buffer_load_dwordx4 v7, s[64:67], s8 offen  lds
    s_add_u32 m0, s80, 3072
    s_add_u32 s8, s81, 98304
    buffer_load_dwordx4 v7, s[64:67], s8 offen  lds
    s_bfe_u32 s81, s91, 0x40014
    s_mul_i32 s81, s81, 131072
    s_add_u32 s81, s81, s82
    s_add_u32 m0, s80, 4096
    s_nop 0
    buffer_load_dwordx4 v7, s[64:67], s81 offen  lds
    s_add_u32 m0, s80, 5120
    s_add_u32 s8, s81, 32768
    buffer_load_dwordx4 v7, s[64:67], s8 offen  lds
    s_add_u32 m0, s80, 6144
    s_add_u32 s8, s81, 65536
    buffer_load_dwordx4 v7, s[64:67], s8 offen  lds
    s_add_u32 m0, s80, 7168
    s_add_u32 s8, s81, 98304
    buffer_load_dwordx4 v7, s[64:67], s8 offen  lds
    s_waitcnt vmcnt(10)
    ds_read_b64_tr_b16 v[160:161], v2 offset:12288
    ds_read_b64_tr_b16 v[162:163], v2 offset:14336
    ds_read_b64_tr_b16 v[164:165], v3 offset:12288
    ds_read_b64_tr_b16 v[166:167], v3 offset:14336
    ds_read_b64_tr_b16 v[168:169], v4 offset:12288
    ds_read_b64_tr_b16 v[170:171], v4 offset:14336
    ds_read_b64_tr_b16 v[172:173], v5 offset:12288
    ds_read_b64_tr_b16 v[174:175], v5 offset:14336
    ds_read_b64_tr_b16 v[176:177], v2 offset:16384
    ds_read_b64_tr_b16 v[178:179], v2 offset:18432
    ds_read_b64_tr_b16 v[180:181], v3 offset:16384
    ds_read_b64_tr_b16 v[182:183], v3 offset:18432
    ds_read_b64_tr_b16 v[184:185], v4 offset:16384
    ds_read_b64_tr_b16 v[186:187], v4 offset:18432
    ds_read_b64_tr_b16 v[188:189], v5 offset:16384
    ds_read_b64_tr_b16 v[190:191], v5 offset:18432
    ds_read_b64_tr_b16 v[192:193], v2 offset:20480
    ds_read_b64_tr_b16 v[194:195], v2 offset:22528
    ds_read_b64_tr_b16 v[196:197], v3 offset:20480
    ds_read_b64_tr_b16 v[198:199], v3 offset:22528
    ds_read_b64_tr_b16 v[200:201], v4 offset:20480
    ds_read_b64_tr_b16 v[202:203], v4 offset:22528
    ds_read_b64_tr_b16 v[204:205], v5 offset:20480
    ds_read_b64_tr_b16 v[206:207], v5 offset:22528
    ds_read_b64_tr_b16 v[208:209], v2 offset:24576
    ds_read_b64_tr_b16 v[210:211], v2 offset:26624
    ds_read_b64_tr_b16 v[212:213], v3 offset:24576
    ds_read_b64_tr_b16 v[214:215], v3 offset:26624
    ds_read_b64_tr_b16 v[216:217], v4 offset:24576
    ds_read_b64_tr_b16 v[218:219], v4 offset:26624
    ds_read_b64_tr_b16 v[220:221], v5 offset:24576
    ds_read_b64_tr_b16 v[222:223], v5 offset:26624
    s_waitcnt lgkmcnt(0)
    s_waitcnt vmcnt(8)
    s_add_u32 s14, s48, s86
    s_addc_u32 s15, s49, 0
    s_mov_b32 s7, 1
    s_atomic_add s7, s[14:15], 0x0
    s_atomic_add s7, s[14:15], 0x400
    s_atomic_add s7, s[14:15], 0x800
    s_atomic_add s7, s[14:15], 0xc00
    s_atomic_add s7, s[14:15], 0x1000
    s_atomic_add s7, s[14:15], 0x1400
    s_atomic_add s7, s[14:15], 0x1800
    s_atomic_add s7, s[14:15], 0x1c00
    buffer_load_dwordx4 v[148:151], v9, s[56:59], s97 offen
    buffer_load_dwordx4 v[152:155], v9, s[56:59], s97 offen offset:64
    buffer_load_dwordx2 v[156:157], v1, s[56:59], s97 offen offset:128
    s_bfe_u32 s81, s91, 0x40018
    s_mul_i32 s81, s81, 131072
    s_add_u32 s81, s81, s82
    s_add_u32 m0, s80, 8192
    s_nop 0
    buffer_load_dwordx4 v7, s[64:67], s81 offen  lds
    s_add_u32 m0, s80, 9216
    s_add_u32 s8, s81, 32768
    buffer_load_dwordx4 v7, s[64:67], s8 offen  lds
    s_add_u32 m0, s80, 10240
    s_add_u32 s8, s81, 65536
    buffer_load_dwordx4 v7, s[64:67], s8 offen  lds
    s_add_u32 m0, s80, 11264
    s_add_u32 s8, s81, 98304
    buffer_load_dwordx4 v7, s[64:67], s8 offen  lds
    s_bfe_u32 s81, s91, 0x4001c
    s_mul_i32 s81, s81, 131072
    s_add_u32 s81, s81, s82
    s_add_u32 m0, s80, 12288
    s_nop 0
    buffer_load_dwordx4 v7, s[64:67], s81 offen  lds
    s_add_u32 m0, s80, 13312
    s_add_u32 s8, s81, 32768
    buffer_load_dwordx4 v7, s[64:67], s8 offen  lds
    s_add_u32 m0, s80, 14336
    s_add_u32 s8, s81, 65536
    buffer_load_dwordx4 v7, s[64:67], s8 offen  lds
    s_add_u32 m0, s80, 15360
    s_add_u32 s8, s81, 98304
    buffer_load_dwordx4 v7, s[64:67], s8 offen  lds
    s_waitcnt vmcnt(15)
    ds_read_b64_tr_b16 v[224:225], v2 offset:0
    ds_read_b64_tr_b16 v[226:227], v2 offset:2048
    ds_read_b64_tr_b16 v[228:229], v3 offset:0
    ds_read_b64_tr_b16 v[230:231], v3 offset:2048
    ds_read_b64_tr_b16 v[232:233], v4 offset:0
    ds_read_b64_tr_b16 v[234:235], v4 offset:2048
    ds_read_b64_tr_b16 v[236:237], v5 offset:0
    ds_read_b64_tr_b16 v[238:239], v5 offset:2048
    s_bfe_u32 s81, s92, 0x40000
    s_mul_i32 s81, s81, 131072
    s_add_u32 s81, s81, s82
    s_add_u32 m0, s80, 16384
    s_nop 0
    buffer_load_dwordx4 v7, s[64:67], s81 offen  lds
    s_add_u32 m0, s80, 17408
    s_add_u32 s8, s81, 32768
    buffer_load_dwordx4 v7, s[64:67], s8 offen  lds
    s_add_u32 m0, s80, 18432
    s_add_u32 s8, s81, 65536
    buffer_load_dwordx4 v7, s[64:67], s8 offen  lds
    s_add_u32 m0, s80, 19456
    s_add_u32 s8, s81, 98304
    buffer_load_dwordx4 v7, s[64:67], s8 offen  lds
    s_waitcnt vmcnt(15)
    ds_read_b64_tr_b16 v[240:241], v2 offset:4096
    ds_read_b64_tr_b16 v[242:243], v2 offset:6144
    ds_read_b64_tr_b16 v[244:245], v3 offset:4096
    ds_read_b64_tr_b16 v[246:247], v3 offset:6144
    ds_read_b64_tr_b16 v[248:249], v4 offset:4096
    ds_read_b64_tr_b16 v[250:251], v4 offset:6144
    ds_read_b64_tr_b16 v[252:253], v5 offset:4096
    ds_read_b64_tr_b16 v[254:255], v5 offset:6144
    s_bfe_u32 s81, s92, 0x40004
    s_mul_i32 s81, s81, 131072
    s_add_u32 s81, s81, s82
    s_add_u32 m0, s80, 20480
    s_nop 0
    buffer_load_dwordx4 v7, s[64:67], s81 offen  lds
    s_add_u32 m0, s80, 21504
    s_add_u32 s8, s81, 32768
    buffer_load_dwordx4 v7, s[64:67], s8 offen  lds
    s_add_u32 m0, s80, 22528
    s_add_u32 s8, s81, 65536
    buffer_load_dwordx4 v7, s[64:67], s8 offen  lds
    s_add_u32 m0, s80, 23552
    s_add_u32 s8, s81, 98304
    buffer_load_dwordx4 v7, s[64:67], s8 offen  lds
    s_waitcnt vmcnt(16)
    s_waitcnt lgkmcnt(0)
    s_and_b32 s9, s2, 63
    s_lshl_b32 s9, s9, 3
    s_add_u32 s9, s9, s3
    s_lshl_b32 s9, s9, 7
    s_add_u32 s9, s9, 0xa80200
    s_add_u32 s14, s48, s9
    s_addc_u32 s15, s49, 0
    s_load_dword s7, s[14:15], 0 glc
    s_bfe_u32 s81, s92, 0x40008
    s_mul_i32 s81, s81, 131072
    s_add_u32 s81, s81, s82
    s_add_u32 m0, s80, 24576
    s_nop 0
    buffer_load_dwordx4 v7, s[64:67], s81 offen  lds
    s_add_u32 m0, s80, 25600
    s_add_u32 s8, s81, 32768
    buffer_load_dwordx4 v7, s[64:67], s8 offen  lds
    s_add_u32 m0, s80, 26624
    s_add_u32 s8, s81, 65536
    buffer_load_dwordx4 v7, s[64:67], s8 offen  lds
    s_add_u32 m0, s80, 27648
    s_add_u32 s8, s81, 98304
    buffer_load_dwordx4 v7, s[64:67], s8 offen  lds
    s_bfe_u32 s81, s92, 0x4000c
    s_mul_i32 s81, s81, 131072
    s_add_u32 s81, s81, s82
    s_add_u32 m0, s80, 0
    s_nop 0
    buffer_load_dwordx4 v7, s[64:67], s81 offen  lds
    s_add_u32 m0, s80, 1024
    s_add_u32 s8, s81, 32768
    buffer_load_dwordx4 v7, s[64:67], s8 offen  lds
    s_add_u32 m0, s80, 2048
    s_add_u32 s8, s81, 65536
    buffer_load_dwordx4 v7, s[64:67], s8 offen  lds
    s_add_u32 m0, s80, 3072
    s_add_u32 s8, s81, 98304
    buffer_load_dwordx4 v7, s[64:67], s8 offen  lds
    s_branch L_g2_pre
L_g2_pre_nog1:
    s_cmp_lg_u32 s5, 31
    s_cbranch_scc1 L_noagg_h
    v_lshlrev_b32 v8, 7, v0
    s_lshl_b32 s9, s3, 13
    s_add_u32 s9, s9, 0xa00000
    v_lshlrev_b32 v12, 13, v0
    v_mov_b32 v13, s6
    s_lshl_b32 s10, s4, 3
    s_add_u32 s10, s10, s3
    s_lshl_b32 s10, s10, 7
    s_add_u32 s10, s10, 0xa80000
    s_mov_b32 s12, 32768
L_poll1:
    buffer_load_dword v9, v8, s[52:55], s9 offen sc1
    s_waitcnt vmcnt(0)
    v_cmp_ne_u32 vcc, s6, v9
    s_nop 0
    s_cmp_eq_u64 vcc, 0
    s_cbranch_scc1 L_pollok1
    s_sub_u32 s12, s12, 1
    s_cmp_eq_u32 s12, 0
    s_cbranch_scc1 L_pollok1
    s_mov_b64 exec, vcc
    s_branch L_poll1
L_pollok1:
    s_mov_b64 exec, -1
    s_mov_b32 exec_hi, 0
    buffer_store_dword v13, v12, s[52:55], s10 offen sc1
    s_mov_b64 exec, -1
L_noagg_h:
    s_lshl_b32 s9, s2, 3
    s_add_u32 s9, s9, s3
    s_lshl_b32 s9, s9, 7
    s_add_u32 s9, s9, 0xa80000
    s_add_u32 s14, s48, s9
    s_addc_u32 s15, s49, 0
    s_mov_b32 s12, 65536
L_sp2:
    s_load_dword s7, s[14:15], 0 glc
L_sq2:
    s_waitcnt lgkmcnt(0)
    s_cmp_eq_u32 s7, s6
    s_cbranch_scc1 L_spok2
    s_sleep 4
    s_sub_u32 s12, s12, 1
    s_cmp_lg_u32 s12, 0
    s_cbranch_scc1 L_sp2
L_spok2:
    v_mov_b32 v12, 47980
    v_mov_b32 v13, 1
    s_mov_b64 exec, 1
    ds_add_u32 v12, v13
    s_mov_b64 exec, -1
    v_mov_b32 v12, 47980
    s_mov_b32 s12, 0x200000
L_lw4:
    ds_read_b32 v13, v12
    s_waitcnt lgkmcnt(0)
    v_readfirstlane_b32 s8, v13
    s_nop 0
    s_cmp_ge_u32 s8, 4
    s_cbranch_scc1 L_lwok4
    s_sleep 2
    s_sub_u32 s12, s12, 1
    s_cmp_lg_u32 s12, 0
    s_cbranch_scc1 L_lw4
L_lwok4:
    s_setprio 2
    v_and_b32 v12, 15, v0
    v_lshrrev_b32 v13, 4, v0
    v_mul_u32_u24 v9, 1280, v12
    v_lshl_add_u32 v1, v13, 3, v9
    v_lshl_add_u32 v9, v13, 4, v9
    s_lshl_b32 s10, s79, 2
    s_add_u32 s10, s10, s3
    s_mul_i32 s97, s10, 20480
    s_mul_i32 s11, s78, 160
    s_add_u32 s97, s97, s11
    buffer_load_dwordx4 v[148:151], v9, s[56:59], s97 offen
    buffer_load_dwordx4 v[152:155], v9, s[56:59], s97 offen offset:64
    buffer_load_dwordx2 v[156:157], v1, s[56:59], s97 offen offset:128
    v_lshrrev_b32 v10, 3, v0
    v_and_b32 v11, 6, v10
    v_and_b32 v12, 7, v0
    v_xor_b32 v12, v12, v11
    v_lshlrev_b32 v12, 4, v12
    s_mov_b32 s8, 4096
    v_mul_lo_u32 v10, v10, s8
    v_add_u32 v7, v10, v12
    s_mul_i32 s82, s3, 1572864
    s_lshl_b32 s8, s79, 7
    s_add_u32 s82, s82, s8
    s_lshl_b32 s8, s3, 5
    v_xor_b32 v2, s8, v2
    v_xor_b32 v3, s8, v3
    v_xor_b32 v4, s8, v4
    v_xor_b32 v5, s8, v5
    s_bfe_u32 s81, s91, 0x40000
    s_mul_i32 s81, s81, 131072
    s_add_u32 s81, s81, s82
    s_add_u32 m0, s80, 12288
    s_nop 0
    buffer_load_dwordx4 v7, s[64:67], s81 offen  lds
    s_add_u32 m0, s80, 13312
    s_add_u32 s8, s81, 32768
    buffer_load_dwordx4 v7, s[64:67], s8 offen  lds
    s_add_u32 m0, s80, 14336
    s_add_u32 s8, s81, 65536
    buffer_load_dwordx4 v7, s[64:67], s8 offen  lds
    s_add_u32 m0, s80, 15360
    s_add_u32 s8, s81, 98304
    buffer_load_dwordx4 v7, s[64:67], s8 offen  lds
    s_bfe_u32 s81, s91, 0x40004
    s_mul_i32 s81, s81, 131072
    s_add_u32 s81, s81, s82
    s_add_u32 m0, s80, 16384
    s_nop 0
    buffer_load_dwordx4 v7, s[64:67], s81 offen  lds
    s_add_u32 m0, s80, 17408
    s_add_u32 s8, s81, 32768
    buffer_load_dwordx4 v7, s[64:67], s8 offen  lds
    s_add_u32 m0, s80, 18432
    s_add_u32 s8, s81, 65536
    buffer_load_dwordx4 v7, s[64:67], s8 offen  lds
    s_add_u32 m0, s80, 19456
    s_add_u32 s8, s81, 98304
    buffer_load_dwordx4 v7, s[64:67], s8 offen  lds
    s_waitcnt vmcnt(4)
    s_bfe_u32 s81, s91, 0x40008
    s_mul_i32 s81, s81, 131072
    s_add_u32 s81, s81, s82
    s_add_u32 m0, s80, 20480
    s_nop 0
    buffer_load_dwordx4 v7, s[64:67], s81 offen  lds
    s_add_u32 m0, s80, 21504
    s_add_u32 s8, s81, 32768
    buffer_load_dwordx4 v7, s[64:67], s8 offen  lds
    s_add_u32 m0, s80, 22528
    s_add_u32 s8, s81, 65536
    buffer_load_dwordx4 v7, s[64:67], s8 offen  lds
    s_add_u32 m0, s80, 23552
    s_add_u32 s8, s81, 98304
    buffer_load_dwordx4 v7, s[64:67], s8 offen  lds
    s_waitcnt vmcnt(4)
    s_bfe_u32 s81, s91, 0x4000c
    s_mul_i32 s81, s81, 131072
    s_add_u32 s81, s81, s82
    s_add_u32 m0, s80, 24576
    s_nop 0
    buffer_load_dwordx4 v7, s[64:67], s81 offen  lds
    s_add_u32 m0, s80, 25600
    s_add_u32 s8, s81, 32768
    buffer_load_dwordx4 v7, s[64:67], s8 offen  lds
    s_add_u32 m0, s80, 26624
    s_add_u32 s8, s81, 65536
    buffer_load_dwordx4 v7, s[64:67], s8 offen  lds
    s_add_u32 m0, s80, 27648
    s_add_u32 s8, s81, 98304
    buffer_load_dwordx4 v7, s[64:67], s8 offen  lds
    s_waitcnt vmcnt(4)
    s_bfe_u32 s81, s91, 0x40010
    s_mul_i32 s81, s81, 131072
    s_add_u32 s81, s81, s82
    s_add_u32 m0, s80, 0
    s_nop 0
    buffer_load_dwordx4 v7, s[64:67], s81 offen  lds
    s_add_u32 m0, s80, 1024
    s_add_u32 s8, s81, 32768
    buffer_load_dwordx4 v7, s[64:67], s8 offen  lds
    s_add_u32 m0, s80, 2048
    s_add_u32 s8, s81, 65536
    buffer_load_dwordx4 v7, s[64:67], s8 offen  lds
    s_add_u32 m0, s80, 3072
    s_add_u32 s8, s81, 98304
    buffer_load_dwordx4 v7, s[64:67], s8 offen  lds
    s_waitcnt vmcnt(4)
    s_bfe_u32 s81, s91, 0x40014
    s_mul_i32 s81, s81, 131072
    s_add_u32 s81, s81, s82
    s_add_u32 m0, s80, 4096
    s_nop 0
    buffer_load_dwordx4 v7, s[64:67], s81 offen  lds
    s_add_u32 m0, s80, 5120
    s_add_u32 s8, s81, 32768
    buffer_load_dwordx4 v7, s[64:67], s8 offen  lds
    s_add_u32 m0, s80, 6144
    s_add_u32 s8, s81, 65536
    buffer_load_dwordx4 v7, s[64:67], s8 offen  lds
    s_add_u32 m0, s80, 7168
    s_add_u32 s8, s81, 98304
    buffer_load_dwordx4 v7, s[64:67], s8 offen  lds
    s_waitcnt vmcnt(4)
    s_bfe_u32 s81, s91, 0x40018
    s_mul_i32 s81, s81, 131072
    s_add_u32 s81, s81, s82
    s_add_u32 m0, s80, 8192
    s_nop 0
    buffer_load_dwordx4 v7, s[64:67], s81 offen  lds
    s_add_u32 m0, s80, 9216
    s_add_u32 s8, s81, 32768
    buffer_load_dwordx4 v7, s[64:67], s8 offen  lds
    s_add_u32 m0, s80, 10240
    s_add_u32 s8, s81, 65536
    buffer_load_dwordx4 v7, s[64:67], s8 offen  lds
    s_add_u32 m0, s80, 11264
    s_add_u32 s8, s81, 98304
    buffer_load_dwordx4 v7, s[64:67], s8 offen  lds
    s_waitcnt vmcnt(4)
    ds_read_b64_tr_b16 v[160:161], v2 offset:12288
    ds_read_b64_tr_b16 v[162:163], v2 offset:14336
    ds_read_b64_tr_b16 v[164:165], v3 offset:12288
    ds_read_b64_tr_b16 v[166:167], v3 offset:14336
    ds_read_b64_tr_b16 v[168:169], v4 offset:12288
    ds_read_b64_tr_b16 v[170:171], v4 offset:14336
    ds_read_b64_tr_b16 v[172:173], v5 offset:12288
    ds_read_b64_tr_b16 v[174:175], v5 offset:14336
    ds_read_b64_tr_b16 v[176:177], v2 offset:16384
    ds_read_b64_tr_b16 v[178:179], v2 offset:18432
    ds_read_b64_tr_b16 v[180:181], v3 offset:16384
    ds_read_b64_tr_b16 v[182:183], v3 offset:18432
    ds_read_b64_tr_b16 v[184:185], v4 offset:16384
    ds_read_b64_tr_b16 v[186:187], v4 offset:18432
    ds_read_b64_tr_b16 v[188:189], v5 offset:16384
    ds_read_b64_tr_b16 v[190:191], v5 offset:18432
    ds_read_b64_tr_b16 v[192:193], v2 offset:20480
    ds_read_b64_tr_b16 v[194:195], v2 offset:22528
    ds_read_b64_tr_b16 v[196:197], v3 offset:20480
    ds_read_b64_tr_b16 v[198:199], v3 offset:22528
    ds_read_b64_tr_b16 v[200:201], v4 offset:20480
    ds_read_b64_tr_b16 v[202:203], v4 offset:22528
    ds_read_b64_tr_b16 v[204:205], v5 offset:20480
    ds_read_b64_tr_b16 v[206:207], v5 offset:22528
    ds_read_b64_tr_b16 v[208:209], v2 offset:24576
    ds_read_b64_tr_b16 v[210:211], v2 offset:26624
    ds_read_b64_tr_b16 v[212:213], v3 offset:24576
    ds_read_b64_tr_b16 v[214:215], v3 offset:26624
    ds_read_b64_tr_b16 v[216:217], v4 offset:24576
    ds_read_b64_tr_b16 v[218:219], v4 offset:26624
    ds_read_b64_tr_b16 v[220:221], v5 offset:24576
    ds_read_b64_tr_b16 v[222:223], v5 offset:26624
    ds_read_b64_tr_b16 v[224:225], v2 offset:0
    ds_read_b64_tr_b16 v[226:227], v2 offset:2048
    ds_read_b64_tr_b16 v[228:229], v3 offset:0
    ds_read_b64_tr_b16 v[230:231], v3 offset:2048
    ds_read_b64_tr_b16 v[232:233], v4 offset:0
    ds_read_b64_tr_b16 v[234:235], v4 offset:2048
    ds_read_b64_tr_b16 v[236:237], v5 offset:0
    ds_read_b64_tr_b16 v[238:239], v5 offset:2048
    ds_read_b64_tr_b16 v[240:241], v2 offset:4096
    ds_read_b64_tr_b16 v[242:243], v2 offset:6144
    ds_read_b64_tr_b16 v[244:245], v3 offset:4096
    ds_read_b64_tr_b16 v[246:247], v3 offset:6144
    ds_read_b64_tr_b16 v[248:249], v4 offset:4096
    ds_read_b64_tr_b16 v[250:251], v4 offset:6144
    ds_read_b64_tr_b16 v[252:253], v5 offset:4096
    ds_read_b64_tr_b16 v[254:255], v5 offset:6144
    s_waitcnt lgkmcnt(0)
    s_bfe_u32 s81, s91, 0x4001c
    s_mul_i32 s81, s81, 131072
    s_add_u32 s81, s81, s82
    s_add_u32 m0, s80, 12288
    s_nop 0
    buffer_load_dwordx4 v7, s[64:67], s81 offen  lds
    s_add_u32 m0, s80, 13312
    s_add_u32 s8, s81, 32768
    buffer_load_dwordx4 v7, s[64:67], s8 offen  lds
    s_add_u32 m0, s80, 14336
    s_add_u32 s8, s81, 65536
    buffer_load_dwordx4 v7, s[64:67], s8 offen  lds
    s_add_u32 m0, s80, 15360
    s_add_u32 s8, s81, 98304
    buffer_load_dwordx4 v7, s[64:67], s8 offen  lds
    s_waitcnt vmcnt(4)
    s_bfe_u32 s81, s92, 0x40000
    s_mul_i32 s81, s81, 131072
    s_add_u32 s81, s81, s82
    s_add_u32 m0, s80, 16384
    s_nop 0
    buffer_load_dwordx4 v7, s[64:67], s81 offen  lds
    s_add_u32 m0, s80, 17408
    s_add_u32 s8, s81, 32768
    buffer_load_dwordx4 v7, s[64:67], s8 offen  lds
    s_add_u32 m0, s80, 18432
    s_add_u32 s8, s81, 65536
    buffer_load_dwordx4 v7, s[64:67], s8 offen  lds
    s_add_u32 m0, s80, 19456
    s_add_u32 s8, s81, 98304
    buffer_load_dwordx4 v7, s[64:67], s8 offen  lds
    s_waitcnt vmcnt(4)
    s_bfe_u32 s81, s92, 0x40004
    s_mul_i32 s81, s81, 131072
    s_add_u32 s81, s81, s82
    s_add_u32 m0, s80, 20480
    s_nop 0
    buffer_load_dwordx4 v7, s[64:67], s81 offen  lds
    s_add_u32 m0, s80, 21504
    s_add_u32 s8, s81, 32768
    buffer_load_dwordx4 v7, s[64:67], s8 offen  lds
    s_add_u32 m0, s80, 22528
    s_add_u32 s8, s81, 65536
    buffer_load_dwordx4 v7, s[64:67], s8 offen  lds
    s_add_u32 m0, s80, 23552
    s_add_u32 s8, s81, 98304
    buffer_load_dwordx4 v7, s[64:67], s8 offen  lds
    s_waitcnt vmcnt(4)
    s_bfe_u32 s81, s92, 0x40008
    s_mul_i32 s81, s81, 131072
    s_add_u32 s81, s81, s82
    s_add_u32 m0, s80, 24576
    s_nop 0
    buffer_load_dwordx4 v7, s[64:67], s81 offen  lds
    s_add_u32 m0, s80, 25600
    s_add_u32 s8, s81, 32768
    buffer_load_dwordx4 v7, s[64:67], s8 offen  lds
    s_add_u32 m0, s80, 26624
    s_add_u32 s8, s81, 65536
    buffer_load_dwordx4 v7, s[64:67], s8 offen  lds
    s_add_u32 m0, s80, 27648
    s_add_u32 s8, s81, 98304
    buffer_load_dwordx4 v7, s[64:67], s8 offen  lds
    s_waitcnt vmcnt(4)
    s_bfe_u32 s81, s92, 0x4000c
    s_mul_i32 s81, s81, 131072
    s_add_u32 s81, s81, s82
    s_add_u32 m0, s80, 0
    s_nop 0
    buffer_load_dwordx4 v7, s[64:67], s81 offen  lds
    s_add_u32 m0, s80, 1024
    s_add_u32 s8, s81, 32768
    buffer_load_dwordx4 v7, s[64:67], s8 offen  lds
    s_add_u32 m0, s80, 2048
    s_add_u32 s8, s81, 65536
    buffer_load_dwordx4 v7, s[64:67], s8 offen  lds
    s_add_u32 m0, s80, 3072
    s_add_u32 s8, s81, 98304
    buffer_load_dwordx4 v7, s[64:67], s8 offen  lds
    s_waitcnt vmcnt(4)
    s_waitcnt vmcnt(0)
    s_and_b32 s9, s2, 63
    s_lshl_b32 s9, s9, 3
    s_add_u32 s9, s9, s3
    s_lshl_b32 s9, s9, 7
    s_add_u32 s9, s9, 0xa80200
    s_add_u32 s14, s48, s9
    s_addc_u32 s15, s49, 0
    s_load_dword s7, s[14:15], 0 glc
L_g2_pre:
    s_mul_i32 s85, s3, 491520
    s_mul_i32 s8, s78, 1280
    s_add_u32 s85, s85, s8
    s_add_u32 s85, s85, 0x500000
    s_mov_b32 s12, 65536
    s_branch L_sq3
L_sp3:
    s_load_dword s7, s[14:15], 0 glc
L_sq3:
    s_waitcnt lgkmcnt(0)
    s_cmp_eq_u32 s7, 30
    s_cbranch_scc1 L_spok3
    s_sub_u32 s12, s12, 1
    s_cmp_lg_u32 s12, 0
    s_cbranch_scc1 L_sp3
L_spok3:
    s_setprio 2
    s_bfe_u32 s84, s91, 0x40000
    s_mul_i32 s84, s84, 40960
    s_add_u32 s84, s84, s85
    buffer_load_dwordx4 v[96:99], v6, s[52:55], s84 offen offset:0 sc1
    buffer_load_dwordx4 v[100:103], v6, s[52:55], s84 offen offset:256 sc1
    buffer_load_dwordx4 v[104:107], v6, s[52:55], s84 offen offset:512 sc1
    buffer_load_dwordx4 v[108:111], v6, s[52:55], s84 offen offset:768 sc1
    buffer_load_dwordx4 v[112:115], v6, s[52:55], s84 offen offset:1024 sc1
    s_bfe_u32 s84, s91, 0x40004
    s_mul_i32 s84, s84, 40960
    s_add_u32 s84, s84, s85
    buffer_load_dwordx4 v[116:119], v6, s[52:55], s84 offen offset:0 sc1
    buffer_load_dwordx4 v[120:123], v6, s[52:55], s84 offen offset:256 sc1
    buffer_load_dwordx4 v[124:127], v6, s[52:55], s84 offen offset:512 sc1
    buffer_load_dwordx4 v[128:131], v6, s[52:55], s84 offen offset:768 sc1
    buffer_load_dwordx4 v[132:135], v6, s[52:55], s84 offen offset:1024 sc1
    s_bfe_u32 s84, s91, 0x40008
    s_mul_i32 s84, s84, 40960
    s_add_u32 s84, s84, s85
    buffer_load_dwordx4 v[136:139], v6, s[52:55], s84 offen offset:0 sc1
    buffer_load_dwordx4 v[140:143], v6, s[52:55], s84 offen offset:256 sc1
    buffer_load_dwordx4 v[144:147], v6, s[52:55], s84 offen offset:512 sc1
    v_and_b32 v12, 15, v0
    s_lshl_b32 s10, s3, 5
    v_lshl_add_u32 v12, v12, 1, s10
    ds_read_u16 v14, v12 offset:48192
    v_lshlrev_b32 v16, 16, v148
    v_and_b32 v17, s13, v148
    v_lshlrev_b32 v18, 16, v149
    v_and_b32 v19, s13, v149
    v_lshlrev_b32 v20, 16, v150
    v_and_b32 v21, s13, v150
    v_lshlrev_b32 v22, 16, v151
    v_and_b32 v23, s13, v151
    v_lshlrev_b32 v24, 16, v152
    v_and_b32 v25, s13, v152
    v_lshlrev_b32 v26, 16, v153
    v_and_b32 v27, s13, v153
    v_lshlrev_b32 v28, 16, v154
    v_and_b32 v29, s13, v154
    v_lshlrev_b32 v30, 16, v155
    v_and_b32 v31, s13, v155
    v_lshlrev_b32 v32, 16, v156
    v_and_b32 v33, s13, v156
    v_lshlrev_b32 v34, 16, v157
    v_and_b32 v35, s13, v157
    s_waitcnt lgkmcnt(0)
    v_lshlrev_b32 v14, 16, v14
    v_add_f32 v16, v14, v16
    v_add_f32 v17, v14, v17
    v_add_f32 v18, v14, v18
    v_add_f32 v19, v14, v19
    v_add_f32 v20, v14, v20
    v_add_f32 v21, v14, v21
    v_add_f32 v22, v14, v22
    v_add_f32 v23, v14, v23
    v_add_f32 v24, v14, v24
    v_add_f32 v25, v14, v25
    v_add_f32 v26, v14, v26
    v_add_f32 v27, v14, v27
    v_add_f32 v28, v14, v28
    v_add_f32 v29, v14, v29
    v_add_f32 v30, v14, v30
    v_add_f32 v31, v14, v31
    v_add_f32 v32, v14, v32
    v_add_f32 v33, v14, v33
    v_add_f32 v34, v14, v34
    v_add_f32 v35, v14, v35
    buffer_load_dwordx4 v[148:151], v6, s[52:55], s84 offen offset:768 sc1
    buffer_load_dwordx4 v[152:155], v6, s[52:55], s84 offen offset:1024 sc1
    s_bfe_u32 s84, s91, 0x4000c
    s_mul_i32 s84, s84, 40960
    s_add_u32 s84, s84, s85
    buffer_load_dwordx4 v[156:159], v6, s[52:55], s84 offen offset:0 sc1
    v_lshlrev_b32 v7, 4, v0
    v_add_u32 v8, s80, v7
    s_xor_b32 s8, s3, 1
    s_mul_i32 s8, s8, 28672
    s_add_u32 s8, s8, 49152
    v_add_u32 v10, s8, v7
    s_xor_b32 s8, s3, 2
    s_mul_i32 s8, s8, 28672
    s_add_u32 s8, s8, 49152
    v_add_u32 v11, s8, v7
    s_xor_b32 s8, s3, 3
    s_mul_i32 s8, s8, 28672
    s_add_u32 s8, s8, 49152
    v_add_u32 v12, s8, v7
    v_lshrrev_b32 v7, 2, v0
    v_lshlrev_b32 v7, 7, v7
    v_and_b32 v14, 3, v0
    v_lshl_add_u32 v7, v14, 3, v7
    s_lshl_b32 s8, s3, 5
    s_add_u32 s8, s8, 37728
    v_add_u32 v13, s8, v7
    s_waitcnt vmcnt(15)
    v_mfma_f32_16x16x32_bf16 v[16:19], v[96:99], v[160:163], v[16:19]
    v_mfma_f32_16x16x32_bf16 v[36:39], v[96:99], v[164:167], 0
    v_mfma_f32_16x16x32_bf16 v[56:59], v[96:99], v[168:171], 0
    v_mfma_f32_16x16x32_bf16 v[76:79], v[96:99], v[172:175], 0
    buffer_load_dwordx4 v[96:99], v6, s[52:55], s84 offen offset:256 sc1
    s_waitcnt vmcnt(15)
    v_mfma_f32_16x16x32_bf16 v[20:23], v[100:103], v[160:163], v[20:23]
    v_mfma_f32_16x16x32_bf16 v[40:43], v[100:103], v[164:167], 0
    v_mfma_f32_16x16x32_bf16 v[60:63], v[100:103], v[168:171], 0
    v_mfma_f32_16x16x32_bf16 v[80:83], v[100:103], v[172:175], 0
    buffer_load_dwordx4 v[100:103], v6, s[52:55], s84 offen offset:512 sc1
    s_waitcnt vmcnt(15)
    v_mfma_f32_16x16x32_bf16 v[24:27], v[104:107], v[160:163], v[24:27]
    v_mfma_f32_16x16x32_bf16 v[44:47], v[104:107], v[164:167], 0
    v_mfma_f32_16x16x32_bf16 v[64:67], v[104:107], v[168:171], 0
    v_mfma_f32_16x16x32_bf16 v[84:87], v[104:107], v[172:175], 0
    buffer_load_dwordx4 v[104:107], v6, s[52:55], s84 offen offset:768 sc1
    s_waitcnt vmcnt(15)
    v_mfma_f32_16x16x32_bf16 v[28:31], v[108:111], v[160:163], v[28:31]
    v_mfma_f32_16x16x32_bf16 v[48:51], v[108:111], v[164:167], 0
    v_mfma_f32_16x16x32_bf16 v[68:71], v[108:111], v[168:171], 0
    v_mfma_f32_16x16x32_bf16 v[88:91], v[108:111], v[172:175], 0
    buffer_load_dwordx4 v[108:111], v6, s[52:55], s84 offen offset:1024 sc1
    s_waitcnt vmcnt(15)
    v_mfma_f32_16x16x32_bf16 v[32:35], v[112:115], v[160:163], v[32:35]
    s_bfe_u32 s84, s91, 0x40010
    v_mfma_f32_16x16x32_bf16 v[52:55], v[112:115], v[164:167], 0
    s_mul_i32 s84, s84, 40960
    v_mfma_f32_16x16x32_bf16 v[72:75], v[112:115], v[168:171], 0
    s_add_u32 s84, s84, s85
    v_mfma_f32_16x16x32_bf16 v[92:95], v[112:115], v[172:175], 0
    buffer_load_dwordx4 v[112:115], v6, s[52:55], s84 offen offset:0 sc1
    s_waitcnt vmcnt(15)
    v_mfma_f32_16x16x32_bf16 v[16:19], v[116:119], v[176:179], v[16:19]
    ds_read_b64_tr_b16 v[160:161], v2 offset:8192
    v_mfma_f32_16x16x32_bf16 v[36:39], v[116:119], v[180:183], v[36:39]
    ds_read_b64_tr_b16 v[162:163], v2 offset:10240
    v_mfma_f32_16x16x32_bf16 v[56:59], v[116:119], v[184:187], v[56:59]
    ds_read_b64_tr_b16 v[164:165], v3 offset:8192
    v_mfma_f32_16x16x32_bf16 v[76:79], v[116:119], v[188:191], v[76:79]
    buffer_load_dwordx4 v[116:119], v6, s[52:55], s84 offen offset:256 sc1
    s_waitcnt vmcnt(15)
    v_mfma_f32_16x16x32_bf16 v[20:23], v[120:123], v[176:179], v[20:23]
    ds_read_b64_tr_b16 v[166:167], v3 offset:10240
    v_mfma_f32_16x16x32_bf16 v[40:43], v[120:123], v[180:183], v[40:43]
    ds_read_b64_tr_b16 v[168:169], v4 offset:8192
    v_mfma_f32_16x16x32_bf16 v[60:63], v[120:123], v[184:187], v[60:63]
    ds_read_b64_tr_b16 v[170:171], v4 offset:10240
    v_mfma_f32_16x16x32_bf16 v[80:83], v[120:123], v[188:191], v[80:83]
    buffer_load_dwordx4 v[120:123], v6, s[52:55], s84 offen offset:512 sc1
    s_waitcnt vmcnt(15)
    v_mfma_f32_16x16x32_bf16 v[24:27], v[124:127], v[176:179], v[24:27]
    ds_read_b64_tr_b16 v[172:173], v5 offset:8192
    v_mfma_f32_16x16x32_bf16 v[44:47], v[124:127], v[180:183], v[44:47]
    ds_read_b64_tr_b16 v[174:175], v5 offset:10240
    v_mfma_f32_16x16x32_bf16 v[64:67], v[124:127], v[184:187], v[64:67]
    v_mfma_f32_16x16x32_bf16 v[84:87], v[124:127], v[188:191], v[84:87]
    buffer_load_dwordx4 v[124:127], v6, s[52:55], s84 offen offset:768 sc1
    s_waitcnt vmcnt(15)
    v_mfma_f32_16x16x32_bf16 v[28:31], v[128:131], v[176:179], v[28:31]
    v_mfma_f32_16x16x32_bf16 v[48:51], v[128:131], v[180:183], v[48:51]
    v_mfma_f32_16x16x32_bf16 v[68:71], v[128:131], v[184:187], v[68:71]
    v_mfma_f32_16x16x32_bf16 v[88:91], v[128:131], v[188:191], v[88:91]
    buffer_load_dwordx4 v[128:131], v6, s[52:55], s84 offen offset:1024 sc1
    s_waitcnt vmcnt(15)
    v_mfma_f32_16x16x32_bf16 v[32:35], v[132:135], v[176:179], v[32:35]
    s_bfe_u32 s84, s91, 0x40014
    v_mfma_f32_16x16x32_bf16 v[52:55], v[132:135], v[180:183], v[52:55]
    s_mul_i32 s84, s84, 40960
    v_mfma_f32_16x16x32_bf16 v[72:75], v[132:135], v[184:187], v[72:75]
    s_add_u32 s84, s84, s85
    v_mfma_f32_16x16x32_bf16 v[92:95], v[132:135], v[188:191], v[92:95]
    buffer_load_dwordx4 v[132:135], v6, s[52:55], s84 offen offset:0 sc1
    s_waitcnt vmcnt(15)
    v_mfma_f32_16x16x32_bf16 v[16:19], v[136:139], v[192:195], v[16:19]
    ds_read_b64_tr_b16 v[176:177], v2 offset:12288
    v_mfma_f32_16x16x32_bf16 v[36:39], v[136:139], v[196:199], v[36:39]
    ds_read_b64_tr_b16 v[178:179], v2 offset:14336
    v_mfma_f32_16x16x32_bf16 v[56:59], v[136:139], v[200:203], v[56:59]
    ds_read_b64_tr_b16 v[180:181], v3 offset:12288
    v_mfma_f32_16x16x32_bf16 v[76:79], v[136:139], v[204:207], v[76:79]
    buffer_load_dwordx4 v[136:139], v6, s[52:55], s84 offen offset:256 sc1
    s_waitcnt vmcnt(15)
    v_mfma_f32_16x16x32_bf16 v[20:23], v[140:143], v[192:195], v[20:23]
    ds_read_b64_tr_b16 v[182:183], v3 offset:14336
    v_mfma_f32_16x16x32_bf16 v[40:43], v[140:143], v[196:199], v[40:43]
    ds_read_b64_tr_b16 v[184:185], v4 offset:12288
    v_mfma_f32_16x16x32_bf16 v[60:63], v[140:143], v[200:203], v[60:63]
    ds_read_b64_tr_b16 v[186:187], v4 offset:14336
    v_mfma_f32_16x16x32_bf16 v[80:83], v[140:143], v[204:207], v[80:83]
    buffer_load_dwordx4 v[140:143], v6, s[52:55], s84 offen offset:512 sc1
    s_waitcnt vmcnt(15)
    v_mfma_f32_16x16x32_bf16 v[24:27], v[144:147], v[192:195], v[24:27]
    ds_read_b64_tr_b16 v[188:189], v5 offset:12288
    v_mfma_f32_16x16x32_bf16 v[44:47], v[144:147], v[196:199], v[44:47]
    ds_read_b64_tr_b16 v[190:191], v5 offset:14336
    v_mfma_f32_16x16x32_bf16 v[64:67], v[144:147], v[200:203], v[64:67]
    v_mfma_f32_16x16x32_bf16 v[84:87], v[144:147], v[204:207], v[84:87]
    buffer_load_dwordx4 v[144:147], v6, s[52:55], s84 offen offset:768 sc1
    s_waitcnt vmcnt(15)
    v_mfma_f32_16x16x32_bf16 v[28:31], v[148:151], v[192:195], v[28:31]
    v_mfma_f32_16x16x32_bf16 v[48:51], v[148:151], v[196:199], v[48:51]
    v_mfma_f32_16x16x32_bf16 v[68:71], v[148:151], v[200:203], v[68:71]
    v_mfma_f32_16x16x32_bf16 v[88:91], v[148:151], v[204:207], v[88:91]
    buffer_load_dwordx4 v[148:151], v6, s[52:55], s84 offen offset:1024 sc1
    s_waitcnt vmcnt(15)
    v_mfma_f32_16x16x32_bf16 v[32:35], v[152:155], v[192:195], v[32:35]
    s_bfe_u32 s84, s91, 0x40018
    v_mfma_f32_16x16x32_bf16 v[52:55], v[152:155], v[196:199], v[52:55]
    s_mul_i32 s84, s84, 40960
    v_mfma_f32_16x16x32_bf16 v[72:75], v[152:155], v[200:203], v[72:75]
    s_add_u32 s84, s84, s85
    v_mfma_f32_16x16x32_bf16 v[92:95], v[152:155], v[204:207], v[92:95]
    buffer_load_dwordx4 v[152:155], v6, s[52:55], s84 offen offset:0 sc1
    s_waitcnt vmcnt(15)
    v_mfma_f32_16x16x32_bf16 v[16:19], v[156:159], v[208:211], v[16:19]
    ds_read_b64_tr_b16 v[192:193], v2 offset:16384
    v_mfma_f32_16x16x32_bf16 v[36:39], v[156:159], v[212:215], v[36:39]
    ds_read_b64_tr_b16 v[194:195], v2 offset:18432
    v_mfma_f32_16x16x32_bf16 v[56:59], v[156:159], v[216:219], v[56:59]
    ds_read_b64_tr_b16 v[196:197], v3 offset:16384
    v_mfma_f32_16x16x32_bf16 v[76:79], v[156:159], v[220:223], v[76:79]
    buffer_load_dwordx4 v[156:159], v6, s[52:55], s84 offen offset:256 sc1
    s_waitcnt vmcnt(15)
    v_mfma_f32_16x16x32_bf16 v[20:23], v[96:99], v[208:211], v[20:23]
    ds_read_b64_tr_b16 v[198:199], v3 offset:18432
    v_mfma_f32_16x16x32_bf16 v[40:43], v[96:99], v[212:215], v[40:43]
    ds_read_b64_tr_b16 v[200:201], v4 offset:16384
    v_mfma_f32_16x16x32_bf16 v[60:63], v[96:99], v[216:219], v[60:63]
    ds_read_b64_tr_b16 v[202:203], v4 offset:18432
    v_mfma_f32_16x16x32_bf16 v[80:83], v[96:99], v[220:223], v[80:83]
    buffer_load_dwordx4 v[96:99], v6, s[52:55], s84 offen offset:512 sc1
    s_waitcnt vmcnt(15)
    v_mfma_f32_16x16x32_bf16 v[24:27], v[100:103], v[208:211], v[24:27]
    ds_read_b64_tr_b16 v[204:205], v5 offset:16384
    v_mfma_f32_16x16x32_bf16 v[44:47], v[100:103], v[212:215], v[44:47]
    ds_read_b64_tr_b16 v[206:207], v5 offset:18432
    v_mfma_f32_16x16x32_bf16 v[64:67], v[100:103], v[216:219], v[64:67]
    v_mfma_f32_16x16x32_bf16 v[84:87], v[100:103], v[220:223], v[84:87]
    buffer_load_dwordx4 v[100:103], v6, s[52:55], s84 offen offset:768 sc1
    s_waitcnt vmcnt(15)
    v_mfma_f32_16x16x32_bf16 v[28:31], v[104:107], v[208:211], v[28:31]
    v_mfma_f32_16x16x32_bf16 v[48:51], v[104:107], v[212:215], v[48:51]
    v_mfma_f32_16x16x32_bf16 v[68:71], v[104:107], v[216:219], v[68:71]
    v_mfma_f32_16x16x32_bf16 v[88:91], v[104:107], v[220:223], v[88:91]
    buffer_load_dwordx4 v[104:107], v6, s[52:55], s84 offen offset:1024 sc1
    s_waitcnt vmcnt(15)
    v_mfma_f32_16x16x32_bf16 v[32:35], v[108:111], v[208:211], v[32:35]
    s_bfe_u32 s84, s91, 0x4001c
    v_mfma_f32_16x16x32_bf16 v[52:55], v[108:111], v[212:215], v[52:55]
    s_mul_i32 s84, s84, 40960
    v_mfma_f32_16x16x32_bf16 v[72:75], v[108:111], v[216:219], v[72:75]
    s_add_u32 s84, s84, s85
    v_mfma_f32_16x16x32_bf16 v[92:95], v[108:111], v[220:223], v[92:95]
    buffer_load_dwordx4 v[108:111], v6, s[52:55], s84 offen offset:0 sc1
    s_waitcnt vmcnt(15)
    v_mfma_f32_16x16x32_bf16 v[16:19], v[112:115], v[224:227], v[16:19]
    ds_read_b64_tr_b16 v[208:209], v2 offset:20480
    v_mfma_f32_16x16x32_bf16 v[36:39], v[112:115], v[228:231], v[36:39]
    ds_read_b64_tr_b16 v[210:211], v2 offset:22528
    v_mfma_f32_16x16x32_bf16 v[56:59], v[112:115], v[232:235], v[56:59]
    ds_read_b64_tr_b16 v[212:213], v3 offset:20480
    v_mfma_f32_16x16x32_bf16 v[76:79], v[112:115], v[236:239], v[76:79]
    buffer_load_dwordx4 v[112:115], v6, s[52:55], s84 offen offset:256 sc1
    s_waitcnt vmcnt(15)
    v_mfma_f32_16x16x32_bf16 v[20:23], v[116:119], v[224:227], v[20:23]
    ds_read_b64_tr_b16 v[214:215], v3 offset:22528
    v_mfma_f32_16x16x32_bf16 v[40:43], v[116:119], v[228:231], v[40:43]
    ds_read_b64_tr_b16 v[216:217], v4 offset:20480
    v_mfma_f32_16x16x32_bf16 v[60:63], v[116:119], v[232:235], v[60:63]
    ds_read_b64_tr_b16 v[218:219], v4 offset:22528
    v_mfma_f32_16x16x32_bf16 v[80:83], v[116:119], v[236:239], v[80:83]
    buffer_load_dwordx4 v[116:119], v6, s[52:55], s84 offen offset:512 sc1
    s_waitcnt vmcnt(15)
    v_mfma_f32_16x16x32_bf16 v[24:27], v[120:123], v[224:227], v[24:27]
    ds_read_b64_tr_b16 v[220:221], v5 offset:20480
    v_mfma_f32_16x16x32_bf16 v[44:47], v[120:123], v[228:231], v[44:47]
    ds_read_b64_tr_b16 v[222:223], v5 offset:22528
    v_mfma_f32_16x16x32_bf16 v[64:67], v[120:123], v[232:235], v[64:67]
    v_mfma_f32_16x16x32_bf16 v[84:87], v[120:123], v[236:239], v[84:87]
    buffer_load_dwordx4 v[120:123], v6, s[52:55], s84 offen offset:768 sc1
    s_waitcnt vmcnt(15)
    v_mfma_f32_16x16x32_bf16 v[28:31], v[124:127], v[224:227], v[28:31]
    v_mfma_f32_16x16x32_bf16 v[48:51], v[124:127], v[228:231], v[48:51]
    v_mfma_f32_16x16x32_bf16 v[68:71], v[124:127], v[232:235], v[68:71]
    v_mfma_f32_16x16x32_bf16 v[88:91], v[124:127], v[236:239], v[88:91]
    buffer_load_dwordx4 v[124:127], v6, s[52:55], s84 offen offset:1024 sc1
    s_waitcnt vmcnt(15)
    v_mfma_f32_16x16x32_bf16 v[32:35], v[128:131], v[224:227], v[32:35]
    s_bfe_u32 s84, s92, 0x40000
    v_mfma_f32_16x16x32_bf16 v[52:55], v[128:131], v[228:231], v[52:55]
    s_mul_i32 s84, s84, 40960
    v_mfma_f32_16x16x32_bf16 v[72:75], v[128:131], v[232:235], v[72:75]
    s_add_u32 s84, s84, s85
    v_mfma_f32_16x16x32_bf16 v[92:95], v[128:131], v[236:239], v[92:95]
    buffer_load_dwordx4 v[128:131], v6, s[52:55], s84 offen offset:0 sc1
    s_waitcnt vmcnt(15)
    v_mfma_f32_16x16x32_bf16 v[16:19], v[132:135], v[240:243], v[16:19]
    ds_read_b64_tr_b16 v[224:225], v2 offset:24576
    v_mfma_f32_16x16x32_bf16 v[36:39], v[132:135], v[244:247], v[36:39]
    ds_read_b64_tr_b16 v[226:227], v2 offset:26624
    v_mfma_f32_16x16x32_bf16 v[56:59], v[132:135], v[248:251], v[56:59]
    ds_read_b64_tr_b16 v[228:229], v3 offset:24576
    v_mfma_f32_16x16x32_bf16 v[76:79], v[132:135], v[252:255], v[76:79]
    buffer_load_dwordx4 v[132:135], v6, s[52:55], s84 offen offset:256 sc1
    s_waitcnt vmcnt(15)
    v_mfma_f32_16x16x32_bf16 v[20:23], v[136:139], v[240:243], v[20:23]
    ds_read_b64_tr_b16 v[230:231], v3 offset:26624
    v_mfma_f32_16x16x32_bf16 v[40:43], v[136:139], v[244:247], v[40:43]
    ds_read_b64_tr_b16 v[232:233], v4 offset:24576
    v_mfma_f32_16x16x32_bf16 v[60:63], v[136:139], v[248:251], v[60:63]
    ds_read_b64_tr_b16 v[234:235], v4 offset:26624
    v_mfma_f32_16x16x32_bf16 v[80:83], v[136:139], v[252:255], v[80:83]
    buffer_load_dwordx4 v[136:139], v6, s[52:55], s84 offen offset:512 sc1
    s_waitcnt vmcnt(15)
    v_mfma_f32_16x16x32_bf16 v[24:27], v[140:143], v[240:243], v[24:27]
    ds_read_b64_tr_b16 v[236:237], v5 offset:24576
    v_mfma_f32_16x16x32_bf16 v[44:47], v[140:143], v[244:247], v[44:47]
    ds_read_b64_tr_b16 v[238:239], v5 offset:26624
    v_mfma_f32_16x16x32_bf16 v[64:67], v[140:143], v[248:251], v[64:67]
    v_mfma_f32_16x16x32_bf16 v[84:87], v[140:143], v[252:255], v[84:87]
    buffer_load_dwordx4 v[140:143], v6, s[52:55], s84 offen offset:768 sc1
    s_waitcnt vmcnt(15)
    v_mfma_f32_16x16x32_bf16 v[28:31], v[144:147], v[240:243], v[28:31]
    v_mfma_f32_16x16x32_bf16 v[48:51], v[144:147], v[244:247], v[48:51]
    v_mfma_f32_16x16x32_bf16 v[68:71], v[144:147], v[248:251], v[68:71]
    v_mfma_f32_16x16x32_bf16 v[88:91], v[144:147], v[252:255], v[88:91]
    buffer_load_dwordx4 v[144:147], v6, s[52:55], s84 offen offset:1024 sc1
    s_waitcnt vmcnt(15)
    v_mfma_f32_16x16x32_bf16 v[32:35], v[148:151], v[240:243], v[32:35]
    s_bfe_u32 s84, s92, 0x40004
    v_mfma_f32_16x16x32_bf16 v[52:55], v[148:151], v[244:247], v[52:55]
    s_mul_i32 s84, s84, 40960
    v_mfma_f32_16x16x32_bf16 v[72:75], v[148:151], v[248:251], v[72:75]
    s_add_u32 s84, s84, s85
    v_mfma_f32_16x16x32_bf16 v[92:95], v[148:151], v[252:255], v[92:95]
    buffer_load_dwordx4 v[148:151], v6, s[52:55], s84 offen offset:0 sc1
    s_waitcnt lgkmcnt(15)
    s_waitcnt vmcnt(15)
    v_mfma_f32_16x16x32_bf16 v[16:19], v[152:155], v[160:163], v[16:19]
    ds_read_b64_tr_b16 v[240:241], v2 offset:0
    v_mfma_f32_16x16x32_bf16 v[36:39], v[152:155], v[164:167], v[36:39]
    ds_read_b64_tr_b16 v[242:243], v2 offset:2048
    v_mfma_f32_16x16x32_bf16 v[56:59], v[152:155], v[168:171], v[56:59]
    ds_read_b64_tr_b16 v[244:245], v3 offset:0
    v_mfma_f32_16x16x32_bf16 v[76:79], v[152:155], v[172:175], v[76:79]
    buffer_load_dwordx4 v[152:155], v6, s[52:55], s84 offen offset:256 sc1
    s_waitcnt vmcnt(15)
    v_mfma_f32_16x16x32_bf16 v[20:23], v[156:159], v[160:163], v[20:23]
    ds_read_b64_tr_b16 v[246:247], v3 offset:2048
    v_mfma_f32_16x16x32_bf16 v[40:43], v[156:159], v[164:167], v[40:43]
    ds_read_b64_tr_b16 v[248:249], v4 offset:0
    v_mfma_f32_16x16x32_bf16 v[60:63], v[156:159], v[168:171], v[60:63]
    ds_read_b64_tr_b16 v[250:251], v4 offset:2048
    v_mfma_f32_16x16x32_bf16 v[80:83], v[156:159], v[172:175], v[80:83]
    buffer_load_dwordx4 v[156:159], v6, s[52:55], s84 offen offset:512 sc1
    s_waitcnt vmcnt(15)
    v_mfma_f32_16x16x32_bf16 v[24:27], v[96:99], v[160:163], v[24:27]
    ds_read_b64_tr_b16 v[252:253], v5 offset:0
    v_mfma_f32_16x16x32_bf16 v[44:47], v[96:99], v[164:167], v[44:47]
    ds_read_b64_tr_b16 v[254:255], v5 offset:2048
    v_mfma_f32_16x16x32_bf16 v[64:67], v[96:99], v[168:171], v[64:67]
    v_mfma_f32_16x16x32_bf16 v[84:87], v[96:99], v[172:175], v[84:87]
    buffer_load_dwordx4 v[96:99], v6, s[52:55], s84 offen offset:768 sc1
    s_waitcnt vmcnt(15)
    v_mfma_f32_16x16x32_bf16 v[28:31], v[100:103], v[160:163], v[28:31]
    v_mfma_f32_16x16x32_bf16 v[48:51], v[100:103], v[164:167], v[48:51]
    v_mfma_f32_16x16x32_bf16 v[68:71], v[100:103], v[168:171], v[68:71]
    v_mfma_f32_16x16x32_bf16 v[88:91], v[100:103], v[172:175], v[88:91]
    buffer_load_dwordx4 v[100:103], v6, s[52:55], s84 offen offset:1024 sc1
    s_waitcnt vmcnt(15)
    v_mfma_f32_16x16x32_bf16 v[32:35], v[104:107], v[160:163], v[32:35]
    s_bfe_u32 s84, s92, 0x40008
    v_mfma_f32_16x16x32_bf16 v[52:55], v[104:107], v[164:167], v[52:55]
    s_mul_i32 s84, s84, 40960
    v_mfma_f32_16x16x32_bf16 v[72:75], v[104:107], v[168:171], v[72:75]
    s_add_u32 s84, s84, s85
    v_mfma_f32_16x16x32_bf16 v[92:95], v[104:107], v[172:175], v[92:95]
    buffer_load_dwordx4 v[104:107], v6, s[52:55], s84 offen offset:0 sc1
    s_waitcnt vmcnt(15)
    v_mfma_f32_16x16x32_bf16 v[16:19], v[108:111], v[176:179], v[16:19]
    v_mfma_f32_16x16x32_bf16 v[36:39], v[108:111], v[180:183], v[36:39]
    v_mfma_f32_16x16x32_bf16 v[56:59], v[108:111], v[184:187], v[56:59]
    v_mfma_f32_16x16x32_bf16 v[76:79], v[108:111], v[188:191], v[76:79]
    buffer_load_dwordx4 v[108:111], v6, s[52:55], s84 offen offset:256 sc1
    s_waitcnt vmcnt(15)
    v_mfma_f32_16x16x32_bf16 v[20:23], v[112:115], v[176:179], v[20:23]
    v_mfma_f32_16x16x32_bf16 v[40:43], v[112:115], v[180:183], v[40:43]
    v_mfma_f32_16x16x32_bf16 v[60:63], v[112:115], v[184:187], v[60:63]
    v_mfma_f32_16x16x32_bf16 v[80:83], v[112:115], v[188:191], v[80:83]
    buffer_load_dwordx4 v[112:115], v6, s[52:55], s84 offen offset:512 sc1
    s_waitcnt vmcnt(15)
    v_mfma_f32_16x16x32_bf16 v[24:27], v[116:119], v[176:179], v[24:27]
    v_mfma_f32_16x16x32_bf16 v[44:47], v[116:119], v[180:183], v[44:47]
    v_mfma_f32_16x16x32_bf16 v[64:67], v[116:119], v[184:187], v[64:67]
    v_mfma_f32_16x16x32_bf16 v[84:87], v[116:119], v[188:191], v[84:87]
    buffer_load_dwordx4 v[116:119], v6, s[52:55], s84 offen offset:768 sc1
    s_waitcnt vmcnt(15)
    v_mfma_f32_16x16x32_bf16 v[28:31], v[120:123], v[176:179], v[28:31]
    v_mfma_f32_16x16x32_bf16 v[48:51], v[120:123], v[180:183], v[48:51]
    v_mfma_f32_16x16x32_bf16 v[68:71], v[120:123], v[184:187], v[68:71]
    v_mfma_f32_16x16x32_bf16 v[88:91], v[120:123], v[188:191], v[88:91]
    buffer_load_dwordx4 v[120:123], v6, s[52:55], s84 offen offset:1024 sc1
    s_waitcnt vmcnt(15)
    v_mfma_f32_16x16x32_bf16 v[32:35], v[124:127], v[176:179], v[32:35]
    s_bfe_u32 s84, s92, 0x4000c
    v_mfma_f32_16x16x32_bf16 v[52:55], v[124:127], v[180:183], v[52:55]
    s_mul_i32 s84, s84, 40960
    v_mfma_f32_16x16x32_bf16 v[72:75], v[124:127], v[184:187], v[72:75]
    s_add_u32 s84, s84, s85
    v_mfma_f32_16x16x32_bf16 v[92:95], v[124:127], v[188:191], v[92:95]
    buffer_load_dwordx4 v[124:127], v6, s[52:55], s84 offen offset:0 sc1
    s_waitcnt vmcnt(15)
    v_mfma_f32_16x16x32_bf16 v[16:19], v[128:131], v[192:195], v[16:19]
    v_mfma_f32_16x16x32_bf16 v[36:39], v[128:131], v[196:199], v[36:39]
    v_mfma_f32_16x16x32_bf16 v[56:59], v[128:131], v[200:203], v[56:59]
    v_mfma_f32_16x16x32_bf16 v[76:79], v[128:131], v[204:207], v[76:79]
    buffer_load_dwordx4 v[128:131], v6, s[52:55], s84 offen offset:256 sc1
    s_waitcnt vmcnt(15)
    v_mfma_f32_16x16x32_bf16 v[20:23], v[132:135], v[192:195], v[20:23]
    v_mfma_f32_16x16x32_bf16 v[40:43], v[132:135], v[196:199], v[40:43]
    v_mfma_f32_16x16x32_bf16 v[60:63], v[132:135], v[200:203], v[60:63]
    v_mfma_f32_16x16x32_bf16 v[80:83], v[132:135], v[204:207], v[80:83]
    buffer_load_dwordx4 v[132:135], v6, s[52:55], s84 offen offset:512 sc1
    s_waitcnt vmcnt(15)
    v_mfma_f32_16x16x32_bf16 v[24:27], v[136:139], v[192:195], v[24:27]
    v_mfma_f32_16x16x32_bf16 v[44:47], v[136:139], v[196:199], v[44:47]
    v_mfma_f32_16x16x32_bf16 v[64:67], v[136:139], v[200:203], v[64:67]
    v_mfma_f32_16x16x32_bf16 v[84:87], v[136:139], v[204:207], v[84:87]
    buffer_load_dwordx4 v[136:139], v6, s[52:55], s84 offen offset:768 sc1
    s_waitcnt vmcnt(15)
    v_mfma_f32_16x16x32_bf16 v[28:31], v[140:143], v[192:195], v[28:31]
    v_mfma_f32_16x16x32_bf16 v[48:51], v[140:143], v[196:199], v[48:51]
    v_mfma_f32_16x16x32_bf16 v[68:71], v[140:143], v[200:203], v[68:71]
    v_mfma_f32_16x16x32_bf16 v[88:91], v[140:143], v[204:207], v[88:91]
    buffer_load_dwordx4 v[140:143], v6, s[52:55], s84 offen offset:1024 sc1
    s_waitcnt vmcnt(15)
    v_mfma_f32_16x16x32_bf16 v[32:35], v[144:147], v[192:195], v[32:35]
    v_mfma_f32_16x16x32_bf16 v[52:55], v[144:147], v[196:199], v[52:55]
    v_mfma_f32_16x16x32_bf16 v[72:75], v[144:147], v[200:203], v[72:75]
    v_mfma_f32_16x16x32_bf16 v[92:95], v[144:147], v[204:207], v[92:95]
    s_waitcnt lgkmcnt(15)
    s_waitcnt vmcnt(14)
    v_mfma_f32_16x16x32_bf16 v[16:19], v[148:151], v[208:211], v[16:19]
    v_mfma_f32_16x16x32_bf16 v[36:39], v[148:151], v[212:215], v[36:39]
    v_mfma_f32_16x16x32_bf16 v[56:59], v[148:151], v[216:219], v[56:59]
    v_mfma_f32_16x16x32_bf16 v[76:79], v[148:151], v[220:223], v[76:79]
    s_waitcnt vmcnt(13)
    v_mfma_f32_16x16x32_bf16 v[20:23], v[152:155], v[208:211], v[20:23]
    v_mfma_f32_16x16x32_bf16 v[40:43], v[152:155], v[212:215], v[40:43]
    v_mfma_f32_16x16x32_bf16 v[60:63], v[152:155], v[216:219], v[60:63]
    v_mfma_f32_16x16x32_bf16 v[80:83], v[152:155], v[220:223], v[80:83]
    s_waitcnt vmcnt(12)
    v_mfma_f32_16x16x32_bf16 v[24:27], v[156:159], v[208:211], v[24:27]
    v_mfma_f32_16x16x32_bf16 v[44:47], v[156:159], v[212:215], v[44:47]
    v_mfma_f32_16x16x32_bf16 v[64:67], v[156:159], v[216:219], v[64:67]
    v_mfma_f32_16x16x32_bf16 v[84:87], v[156:159], v[220:223], v[84:87]
    s_waitcnt vmcnt(11)
    v_mfma_f32_16x16x32_bf16 v[28:31], v[96:99], v[208:211], v[28:31]
    v_mfma_f32_16x16x32_bf16 v[48:51], v[96:99], v[212:215], v[48:51]
    v_mfma_f32_16x16x32_bf16 v[68:71], v[96:99], v[216:219], v[68:71]
    v_mfma_f32_16x16x32_bf16 v[88:91], v[96:99], v[220:223], v[88:91]
    s_waitcnt vmcnt(10)
    v_mfma_f32_16x16x32_bf16 v[32:35], v[100:103], v[208:211], v[32:35]
    v_mfma_f32_16x16x32_bf16 v[52:55], v[100:103], v[212:215], v[52:55]
    v_mfma_f32_16x16x32_bf16 v[72:75], v[100:103], v[216:219], v[72:75]
    v_mfma_f32_16x16x32_bf16 v[92:95], v[100:103], v[220:223], v[92:95]
    s_waitcnt lgkmcnt(8)
    s_waitcnt vmcnt(9)
    v_mfma_f32_16x16x32_bf16 v[16:19], v[104:107], v[224:227], v[16:19]
    v_mfma_f32_16x16x32_bf16 v[36:39], v[104:107], v[228:231], v[36:39]
    v_mfma_f32_16x16x32_bf16 v[56:59], v[104:107], v[232:235], v[56:59]
    v_mfma_f32_16x16x32_bf16 v[76:79], v[104:107], v[236:239], v[76:79]
    s_waitcnt vmcnt(8)
    v_mfma_f32_16x16x32_bf16 v[20:23], v[108:111], v[224:227], v[20:23]
    v_mfma_f32_16x16x32_bf16 v[40:43], v[108:111], v[228:231], v[40:43]
    v_mfma_f32_16x16x32_bf16 v[60:63], v[108:111], v[232:235], v[60:63]
    v_mfma_f32_16x16x32_bf16 v[80:83], v[108:111], v[236:239], v[80:83]
    s_waitcnt vmcnt(7)
    v_mfma_f32_16x16x32_bf16 v[24:27], v[112:115], v[224:227], v[24:27]
    v_mfma_f32_16x16x32_bf16 v[44:47], v[112:115], v[228:231], v[44:47]
    v_mfma_f32_16x16x32_bf16 v[64:67], v[112:115], v[232:235], v[64:67]
    v_mfma_f32_16x16x32_bf16 v[84:87], v[112:115], v[236:239], v[84:87]
    s_waitcnt vmcnt(6)
    v_mfma_f32_16x16x32_bf16 v[28:31], v[116:119], v[224:227], v[28:31]
    v_mfma_f32_16x16x32_bf16 v[48:51], v[116:119], v[228:231], v[48:51]
    v_mfma_f32_16x16x32_bf16 v[68:71], v[116:119], v[232:235], v[68:71]
    v_mfma_f32_16x16x32_bf16 v[88:91], v[116:119], v[236:239], v[88:91]
    s_waitcnt vmcnt(5)
    v_mfma_f32_16x16x32_bf16 v[32:35], v[120:123], v[224:227], v[32:35]
    v_mfma_f32_16x16x32_bf16 v[52:55], v[120:123], v[228:231], v[52:55]
    v_mfma_f32_16x16x32_bf16 v[72:75], v[120:123], v[232:235], v[72:75]
    v_mfma_f32_16x16x32_bf16 v[92:95], v[120:123], v[236:239], v[92:95]
    s_waitcnt lgkmcnt(0)
    s_waitcnt vmcnt(4)
    v_mfma_f32_16x16x32_bf16 v[36:39], v[124:127], v[244:247], v[36:39]
    v_mfma_f32_16x16x32_bf16 v[56:59], v[124:127], v[248:251], v[56:59]
    v_mfma_f32_16x16x32_bf16 v[76:79], v[124:127], v[252:255], v[76:79]
    v_mfma_f32_16x16x32_bf16 v[16:19], v[124:127], v[240:243], v[16:19]
    s_waitcnt vmcnt(3)
    v_mfma_f32_16x16x32_bf16 v[40:43], v[128:131], v[244:247], v[40:43]
    v_mfma_f32_16x16x32_bf16 v[60:63], v[128:131], v[248:251], v[60:63]
    v_mfma_f32_16x16x32_bf16 v[80:83], v[128:131], v[252:255], v[80:83]
    v_mfma_f32_16x16x32_bf16 v[20:23], v[128:131], v[240:243], v[20:23]
    s_waitcnt vmcnt(2)
    v_mfma_f32_16x16x32_bf16 v[44:47], v[132:135], v[244:247], v[44:47]
    ds_write_b128 v8, v[36:39] offset:0
    v_mfma_f32_16x16x32_bf16 v[64:67], v[132:135], v[248:251], v[64:67]
    ds_write_b128 v8, v[56:59] offset:5120
    v_mfma_f32_16x16x32_bf16 v[84:87], v[132:135], v[252:255], v[84:87]
    ds_write_b128 v8, v[76:79] offset:10240
    v_mfma_f32_16x16x32_bf16 v[24:27], v[132:135], v[240:243], v[24:27]
    s_waitcnt vmcnt(1)
    v_mfma_f32_16x16x32_bf16 v[48:51], v[136:139], v[244:247], v[48:51]
    ds_write_b128 v8, v[40:43] offset:1024
    v_mfma_f32_16x16x32_bf16 v[68:71], v[136:139], v[248:251], v[68:71]
    ds_write_b128 v8, v[60:63] offset:6144
    v_mfma_f32_16x16x32_bf16 v[88:91], v[136:139], v[252:255], v[88:91]
    ds_write_b128 v8, v[80:83] offset:11264
    v_mfma_f32_16x16x32_bf16 v[28:31], v[136:139], v[240:243], v[28:31]
    s_waitcnt vmcnt(0)
    v_mfma_f32_16x16x32_bf16 v[52:55], v[140:143], v[244:247], v[52:55]
    ds_write_b128 v8, v[44:47] offset:2048
    v_mfma_f32_16x16x32_bf16 v[72:75], v[140:143], v[248:251], v[72:75]
    ds_write_b128 v8, v[64:67] offset:7168
    v_mfma_f32_16x16x32_bf16 v[92:95], v[140:143], v[252:255], v[92:95]
    ds_write_b128 v8, v[84:87] offset:12288
    v_mfma_f32_16x16x32_bf16 v[32:35], v[140:143], v[240:243], v[32:35]
    ds_write_b128 v8, v[48:51] offset:3072
    ds_write_b128 v8, v[68:71] offset:8192
    ds_write_b128 v8, v[88:91] offset:13312
    ds_write_b128 v8, v[52:55] offset:4096
    ds_write_b128 v8, v[72:75] offset:9216
    s_nop 0
    ds_write_b128 v8, v[92:95] offset:14336
    s_waitcnt lgkmcnt(0)
    s_barrier
L_ep2:
    ds_read_b64_tr_b16 v[200:201], v13 offset:0
    ds_read_b64_tr_b16 v[202:203], v13 offset:2048
    ds_read_b64_tr_b16 v[204:205], v13 offset:4096
    ds_read_b64_tr_b16 v[206:207], v13 offset:6144
    ds_read_b64_tr_b16 v[208:209], v13 offset:8192
    ds_read_b128 v[36:39], v10 offset:0
    ds_read_b128 v[56:59], v11 offset:5120
    ds_read_b128 v[76:79], v12 offset:10240
    ds_read_b128 v[40:43], v10 offset:1024
    ds_read_b128 v[60:63], v11 offset:6144
    ds_read_b128 v[80:83], v12 offset:11264
    ds_read_b128 v[44:47], v10 offset:2048
    ds_read_b128 v[64:67], v11 offset:7168
    ds_read_b128 v[84:87], v12 offset:12288
    ds_read_b128 v[48:51], v10 offset:3072
    ds_read_b128 v[68:71], v11 offset:8192
    ds_read_b128 v[88:91], v12 offset:13312
    ds_read_b128 v[52:55], v10 offset:4096
    ds_read_b128 v[72:75], v11 offset:9216
    ds_read_b128 v[92:95], v12 offset:14336
    s_waitcnt lgkmcnt(15)
    v_lshlrev_b32 v160, 16, v200
    v_and_b32 v161, s13, v200
    v_lshlrev_b32 v162, 16, v201
    v_and_b32 v163, s13, v201
    v_lshlrev_b32 v164, 16, v202
    v_and_b32 v165, s13, v202
    v_lshlrev_b32 v166, 16, v203
    v_and_b32 v167, s13, v203
    v_lshlrev_b32 v168, 16, v204
    v_and_b32 v169, s13, v204
    v_lshlrev_b32 v170, 16, v205
    v_and_b32 v171, s13, v205
    v_lshlrev_b32 v172, 16, v206
    v_and_b32 v173, s13, v206
    v_lshlrev_b32 v174, 16, v207
    v_and_b32 v175, s13, v207
    v_lshlrev_b32 v176, 16, v208
    v_and_b32 v177, s13, v208
    v_lshlrev_b32 v178, 16, v209
    v_and_b32 v179, s13, v209
    v_pk_add_f32 v[16:17], v[16:17], v[160:161]
    v_pk_add_f32 v[18:19], v[18:19], v[162:163]
    v_pk_add_f32 v[20:21], v[20:21], v[164:165]
    v_pk_add_f32 v[22:23], v[22:23], v[166:167]
    v_pk_add_f32 v[24:25], v[24:25], v[168:169]
    v_pk_add_f32 v[26:27], v[26:27], v[170:171]
    v_pk_add_f32 v[28:29], v[28:29], v[172:173]
    v_pk_add_f32 v[30:31], v[30:31], v[174:175]
    v_pk_add_f32 v[32:33], v[32:33], v[176:177]
    v_pk_add_f32 v[34:35], v[34:35], v[178:179]
    s_waitcnt lgkmcnt(9)
    v_pk_add_f32 v[16:17], v[16:17], v[36:37]
    v_pk_add_f32 v[18:19], v[18:19], v[38:39]
    v_pk_add_f32 v[20:21], v[20:21], v[40:41]
    v_pk_add_f32 v[22:23], v[22:23], v[42:43]
    v_pk_add_f32 v[56:57], v[56:57], v[76:77]
    v_pk_add_f32 v[58:59], v[58:59], v[78:79]
    v_pk_add_f32 v[60:61], v[60:61], v[80:81]
    v_pk_add_f32 v[62:63], v[62:63], v[82:83]
    v_pk_add_f32 v[16:17], v[16:17], v[56:57]
    v_pk_add_f32 v[18:19], v[18:19], v[58:59]
    v_pk_add_f32 v[20:21], v[20:21], v[60:61]
    v_pk_add_f32 v[22:23], v[22:23], v[62:63]
    v_cvt_pk_bf16_f32 v180, v16, v17
    v_cvt_pk_bf16_f32 v181, v18, v19
    v_cvt_pk_bf16_f32 v182, v20, v21
    v_cvt_pk_bf16_f32 v183, v22, v23
    buffer_store_dwordx4 v[180:183], v9, s[68:71], s97 offen offset:0
    s_waitcnt lgkmcnt(3)
    v_pk_add_f32 v[24:25], v[24:25], v[44:45]
    v_pk_add_f32 v[26:27], v[26:27], v[46:47]
    v_pk_add_f32 v[28:29], v[28:29], v[48:49]
    v_pk_add_f32 v[30:31], v[30:31], v[50:51]
    v_pk_add_f32 v[64:65], v[64:65], v[84:85]
    v_pk_add_f32 v[66:67], v[66:67], v[86:87]
    v_pk_add_f32 v[68:69], v[68:69], v[88:89]
    v_pk_add_f32 v[70:71], v[70:71], v[90:91]
    v_pk_add_f32 v[24:25], v[24:25], v[64:65]
    v_pk_add_f32 v[26:27], v[26:27], v[66:67]
    v_pk_add_f32 v[28:29], v[28:29], v[68:69]
    v_pk_add_f32 v[30:31], v[30:31], v[70:71]
    v_cvt_pk_bf16_f32 v184, v24, v25
    v_cvt_pk_bf16_f32 v185, v26, v27
    v_cvt_pk_bf16_f32 v186, v28, v29
    v_cvt_pk_bf16_f32 v187, v30, v31
    buffer_store_dwordx4 v[184:187], v9, s[68:71], s97 offen offset:64
    s_waitcnt lgkmcnt(0)
    v_pk_add_f32 v[32:33], v[32:33], v[52:53]
    v_pk_add_f32 v[34:35], v[34:35], v[54:55]
    v_pk_add_f32 v[72:73], v[72:73], v[92:93]
    v_pk_add_f32 v[74:75], v[74:75], v[94:95]
    v_pk_add_f32 v[32:33], v[32:33], v[72:73]
    v_pk_add_f32 v[34:35], v[34:35], v[74:75]
    v_cvt_pk_bf16_f32 v188, v32, v33
    v_cvt_pk_bf16_f32 v189, v34, v35
    buffer_store_dwordx2 v[188:189], v1, s[68:71], s97 offen offset:128
    s_waitcnt vmcnt(0) lgkmcnt(0)
    s_endpgm
L_aux_main:
    s_and_b32 s8, s5, 1
    s_add_u32 s8, s8, s3
    s_cmp_ge_u32 s8, 7
    s_cbranch_scc1 L_aux_done
    s_waitcnt vmcnt(0)
    v_lshlrev_b32 v64, 16, v84
    v_and_b32 v70, s13, v84
    v_lshlrev_b32 v76, 16, v90
    v_lshlrev_b32 v65, 16, v85
    v_and_b32 v71, s13, v85
    v_lshlrev_b32 v77, 16, v91
    v_lshlrev_b32 v66, 16, v86
    v_and_b32 v72, s13, v86
    v_lshlrev_b32 v78, 16, v92
    v_lshlrev_b32 v67, 16, v87
    v_and_b32 v73, s13, v87
    v_lshlrev_b32 v79, 16, v93
    v_lshlrev_b32 v68, 16, v88
    v_and_b32 v74, s13, v88
    v_lshlrev_b32 v80, 16, v94
    v_lshlrev_b32 v69, 16, v89
    v_and_b32 v75, s13, v89
    v_lshlrev_b32 v81, 16, v95
    v_lshlrev_b32 v82, 16, v96
    v_lshlrev_b32 v83, 16, v97
    v_mul_f32 v82, 0x3fb8aa3b, v82
    v_exp_f32 v82, v82
    s_nop 0
    v_cvt_pk_bf16_f32 v82, v82, v82
    v_and_b32 v82, s13, v82
    s_setprio 0
    s_mov_b32 m0, s95
    v_and_b32 v1, 15, v0
    v_mul_u32_u24 v1, 288, v1
    v_and_b32 v188, 48, v0
    v_add3_u32 v188, v188, v1, s95
    v_mov_b32 v176, 0
    v_mov_b32 v177, 0
    v_mov_b32 v178, 0
    v_mov_b32 v179, 0
    v_mov_b32 v180, 0
    v_mov_b32 v181, 0
    v_mov_b32 v182, 0
    v_mov_b32 v183, 0
    v_mov_b32 v184, 0
    v_mov_b32 v185, 0
    v_mov_b32 v186, 0
    v_mov_b32 v187, 0
    v_mov_b32 v143, 0x3f80
    s_mov_b32 s11, 3
L_kgen:
    v_pk_mul_f32 v[126:127], v[64:65], v[82:83] op_sel_hi:[1,0]
    v_pk_mul_f32 v[128:129], v[66:67], v[82:83] op_sel_hi:[1,0]
    v_mul_f32 v126, 0x3fb8aa3b, v126
    v_mul_f32 v127, 0.15915494, v127
    v_pk_mul_f32 v[118:119], v[68:69], v[128:129] op_sel:[0,0] op_sel_hi:[0,1]
    v_exp_f32 v134, v126
    v_fract_f32 v135, v127
    v_mul_f32 v136, 0x41000000, v126
    v_mul_f32 v137, 0x41000000, v127
    v_exp_f32 v136, v136
    v_fract_f32 v137, v137
    v_mul_f32 v138, 0x43000000, v126
    v_mul_f32 v139, 0x43000000, v127
    v_exp_f32 v138, v138
    v_fract_f32 v139, v139
    v_pk_fma_f32 v[118:119], v[68:69], v[128:129], v[118:119] op_sel:[1,1,0] op_sel_hi:[1,0,1] neg_lo:[1,0,0]
    v_cos_f32 v84, v135
    v_sin_f32 v85, v135
    v_cos_f32 v114, v137
    v_sin_f32 v115, v137
    v_cos_f32 v98, v139
    v_sin_f32 v99, v139
    v_pk_mul_f32 v[84:85], v[84:85], v[134:135] op_sel_hi:[1,0]
    v_pk_mul_f32 v[114:115], v[114:115], v[136:137] op_sel_hi:[1,0]
    v_pk_mul_f32 v[98:99], v[98:99], v[138:139] op_sel_hi:[1,0]
    v_mov_b32 v64, v70
    v_mov_b32 v65, v71
    v_mov_b32 v66, v72
    v_mov_b32 v67, v73
    v_mov_b32 v68, v74
    v_mov_b32 v69, v75
    v_mov_b32 v70, v76
    v_mov_b32 v71, v77
    v_mov_b32 v72, v78
    v_mov_b32 v73, v79
    v_mov_b32 v74, v80
    v_mov_b32 v75, v81
    v_cvt_pk_bf16_f32 v16, v118, -v119
    v_cvt_pk_bf16_f32 v17, v84, v85
    v_cvt_pk_bf16_f32 v18, v98, v99
    v_pk_mul_f32 v[120:121], v[118:119], v[114:115] op_sel:[0,0] op_sel_hi:[0,1]
    v_pk_mul_f32 v[116:117], v[114:115], v[114:115] op_sel:[0,0] op_sel_hi:[0,1]
    v_pk_mul_f32 v[86:87], v[84:85], v[84:85] op_sel:[0,0] op_sel_hi:[0,1]
    v_pk_mul_f32 v[100:101], v[98:99], v[98:99] op_sel:[0,0] op_sel_hi:[0,1]
    v_pk_fma_f32 v[120:121], v[118:119], v[114:115], v[120:121] op_sel:[1,1,0] op_sel_hi:[1,0,1] neg_lo:[1,0,0]
    v_pk_fma_f32 v[116:117], v[114:115], v[114:115], v[116:117] op_sel:[1,1,0] op_sel_hi:[1,0,1] neg_lo:[1,0,0]
    v_pk_fma_f32 v[86:87], v[84:85], v[84:85], v[86:87] op_sel:[1,1,0] op_sel_hi:[1,0,1] neg_lo:[1,0,0]
    v_pk_fma_f32 v[100:101], v[98:99], v[98:99], v[100:101] op_sel:[1,1,0] op_sel_hi:[1,0,1] neg_lo:[1,0,0]
    v_cvt_pk_bf16_f32 v19, v120, -v121
    v_cvt_pk_bf16_f32 v20, v86, v87
    v_cvt_pk_bf16_f32 v21, v100, v101
    v_pk_mul_f32 v[122:123], v[118:119], v[116:117] op_sel:[0,0] op_sel_hi:[0,1]
    v_pk_mul_f32 v[124:125], v[120:121], v[116:117] op_sel:[0,0] op_sel_hi:[0,1]
    v_pk_mul_f32 v[88:89], v[86:87], v[84:85] op_sel:[0,0] op_sel_hi:[0,1]
    v_pk_mul_f32 v[90:91], v[86:87], v[86:87] op_sel:[0,0] op_sel_hi:[0,1]
    v_pk_fma_f32 v[122:123], v[118:119], v[116:117], v[122:123] op_sel:[1,1,0] op_sel_hi:[1,0,1] neg_lo:[1,0,0]
    v_pk_fma_f32 v[124:125], v[120:121], v[116:117], v[124:125] op_sel:[1,1,0] op_sel_hi:[1,0,1] neg_lo:[1,0,0]
    v_pk_fma_f32 v[88:89], v[86:87], v[84:85], v[88:89] op_sel:[1,1,0] op_sel_hi:[1,0,1] neg_lo:[1,0,0]
    v_pk_fma_f32 v[90:91], v[86:87], v[86:87], v[90:91] op_sel:[1,1,0] op_sel_hi:[1,0,1] neg_lo:[1,0,0]
    v_cvt_pk_bf16_f32 v22, v122, -v123
    v_cvt_pk_bf16_f32 v23, v124, -v125
    v_cvt_pk_bf16_f32 v24, v88, v89
    v_cvt_pk_bf16_f32 v25, v90, v91
    v_pk_mul_f32 v[118:119], v[122:123], v[116:117] op_sel:[0,0] op_sel_hi:[0,1]
    v_pk_mul_f32 v[120:121], v[124:125], v[116:117] op_sel:[0,0] op_sel_hi:[0,1]
    v_pk_mul_f32 v[92:93], v[90:91], v[84:85] op_sel:[0,0] op_sel_hi:[0,1]
    v_pk_mul_f32 v[94:95], v[90:91], v[86:87] op_sel:[0,0] op_sel_hi:[0,1]
    v_pk_fma_f32 v[118:119], v[122:123], v[116:117], v[118:119] op_sel:[1,1,0] op_sel_hi:[1,0,1] neg_lo:[1,0,0]
    v_pk_fma_f32 v[120:121], v[124:125], v[116:117], v[120:121] op_sel:[1,1,0] op_sel_hi:[1,0,1] neg_lo:[1,0,0]
    v_pk_fma_f32 v[92:93], v[90:91], v[84:85], v[92:93] op_sel:[1,1,0] op_sel_hi:[1,0,1] neg_lo:[1,0,0]
    v_pk_fma_f32 v[94:95], v[90:91], v[86:87], v[94:95] op_sel:[1,1,0] op_sel_hi:[1,0,1] neg_lo:[1,0,0]
    v_cvt_pk_bf16_f32 v26, v118, -v119
    v_cvt_pk_bf16_f32 v27, v120, -v121
    v_cvt_pk_bf16_f32 v28, v92, v93
    v_cvt_pk_bf16_f32 v29, v94, v95
    v_pk_mul_f32 v[122:123], v[118:119], v[116:117] op_sel:[0,0] op_sel_hi:[0,1]
    v_pk_mul_f32 v[124:125], v[120:121], v[116:117] op_sel:[0,0] op_sel_hi:[0,1]
    v_pk_mul_f32 v[96:97], v[90:91], v[88:89] op_sel:[0,0] op_sel_hi:[0,1]
    v_pk_mul_f32 v[102:103], v[100:101], v[98:99] op_sel:[0,0] op_sel_hi:[0,1]
    v_pk_fma_f32 v[122:123], v[118:119], v[116:117], v[122:123] op_sel:[1,1,0] op_sel_hi:[1,0,1] neg_lo:[1,0,0]
    v_pk_fma_f32 v[124:125], v[120:121], v[116:117], v[124:125] op_sel:[1,1,0] op_sel_hi:[1,0,1] neg_lo:[1,0,0]
    v_pk_fma_f32 v[96:97], v[90:91], v[88:89], v[96:97] op_sel:[1,1,0] op_sel_hi:[1,0,1] neg_lo:[1,0,0]
    v_pk_fma_f32 v[102:103], v[100:101], v[98:99], v[102:103] op_sel:[1,1,0] op_sel_hi:[1,0,1] neg_lo:[1,0,0]
    v_cvt_pk_bf16_f32 v30, v122, -v123
    v_cvt_pk_bf16_f32 v31, v124, -v125
    v_cvt_pk_bf16_f32 v32, v96, v97
    v_cvt_pk_bf16_f32 v33, v102, v103
    v_pk_mul_f32 v[118:119], v[122:123], v[116:117] op_sel:[0,0] op_sel_hi:[0,1]
    v_pk_mul_f32 v[120:121], v[124:125], v[116:117] op_sel:[0,0] op_sel_hi:[0,1]
    v_pk_mul_f32 v[126:127], v[98:99], v[84:85] op_sel:[0,0] op_sel_hi:[0,1]
    v_pk_mul_f32 v[128:129], v[98:99], v[86:87] op_sel:[0,0] op_sel_hi:[0,1]
    v_pk_fma_f32 v[118:119], v[122:123], v[116:117], v[118:119] op_sel:[1,1,0] op_sel_hi:[1,0,1] neg_lo:[1,0,0]
    v_pk_fma_f32 v[120:121], v[124:125], v[116:117], v[120:121] op_sel:[1,1,0] op_sel_hi:[1,0,1] neg_lo:[1,0,0]
    v_pk_fma_f32 v[126:127], v[98:99], v[84:85], v[126:127] op_sel:[1,1,0] op_sel_hi:[1,0,1] neg_lo:[1,0,0]
    v_pk_fma_f32 v[128:129], v[98:99], v[86:87], v[128:129] op_sel:[1,1,0] op_sel_hi:[1,0,1] neg_lo:[1,0,0]
    v_cvt_pk_bf16_f32 v34, v118, -v119
    v_cvt_pk_bf16_f32 v35, v120, -v121
    v_cvt_pk_bf16_f32 v36, v126, v127
    v_cvt_pk_bf16_f32 v37, v128, v129
    v_pk_mul_f32 v[122:123], v[118:119], v[116:117] op_sel:[0,0] op_sel_hi:[0,1]
    v_pk_mul_f32 v[124:125], v[120:121], v[116:117] op_sel:[0,0] op_sel_hi:[0,1]
    v_pk_mul_f32 v[126:127], v[98:99], v[88:89] op_sel:[0,0] op_sel_hi:[0,1]
    v_pk_mul_f32 v[128:129], v[98:99], v[90:91] op_sel:[0,0] op_sel_hi:[0,1]
    v_pk_fma_f32 v[122:123], v[118:119], v[116:117], v[122:123] op_sel:[1,1,0] op_sel_hi:[1,0,1] neg_lo:[1,0,0]
    v_pk_fma_f32 v[124:125], v[120:121], v[116:117], v[124:125] op_sel:[1,1,0] op_sel_hi:[1,0,1] neg_lo:[1,0,0]
    v_pk_fma_f32 v[126:127], v[98:99], v[88:89], v[126:127] op_sel:[1,1,0] op_sel_hi:[1,0,1] neg_lo:[1,0,0]
    v_pk_fma_f32 v[128:129], v[98:99], v[90:91], v[128:129] op_sel:[1,1,0] op_sel_hi:[1,0,1] neg_lo:[1,0,0]
    v_cvt_pk_bf16_f32 v38, v122, -v123
    v_cvt_pk_bf16_f32 v39, v124, -v125
    v_cvt_pk_bf16_f32 v40, v126, v127
    v_cvt_pk_bf16_f32 v41, v128, v129
    v_pk_mul_f32 v[118:119], v[122:123], v[116:117] op_sel:[0,0] op_sel_hi:[0,1]
    v_pk_mul_f32 v[120:121], v[124:125], v[116:117] op_sel:[0,0] op_sel_hi:[0,1]
    v_pk_mul_f32 v[126:127], v[98:99], v[92:93] op_sel:[0,0] op_sel_hi:[0,1]
    v_pk_mul_f32 v[128:129], v[98:99], v[94:95] op_sel:[0,0] op_sel_hi:[0,1]
    v_pk_fma_f32 v[118:119], v[122:123], v[116:117], v[118:119] op_sel:[1,1,0] op_sel_hi:[1,0,1] neg_lo:[1,0,0]
    v_pk_fma_f32 v[120:121], v[124:125], v[116:117], v[120:121] op_sel:[1,1,0] op_sel_hi:[1,0,1] neg_lo:[1,0,0]
    v_pk_fma_f32 v[126:127], v[98:99], v[92:93], v[126:127] op_sel:[1,1,0] op_sel_hi:[1,0,1] neg_lo:[1,0,0]
    v_pk_fma_f32 v[128:129], v[98:99], v[94:95], v[128:129] op_sel:[1,1,0] op_sel_hi:[1,0,1] neg_lo:[1,0,0]
    v_cvt_pk_bf16_f32 v42, v118, -v119
    v_cvt_pk_bf16_f32 v43, v120, -v121
    v_cvt_pk_bf16_f32 v44, v126, v127
    v_cvt_pk_bf16_f32 v45, v128, v129
    v_pk_mul_f32 v[122:123], v[118:119], v[116:117] op_sel:[0,0] op_sel_hi:[0,1]
    v_pk_mul_f32 v[124:125], v[120:121], v[116:117] op_sel:[0,0] op_sel_hi:[0,1]
    v_pk_mul_f32 v[126:127], v[98:99], v[96:97] op_sel:[0,0] op_sel_hi:[0,1]
    v_pk_mul_f32 v[104:105], v[100:101], v[100:101] op_sel:[0,0] op_sel_hi:[0,1]
    v_pk_fma_f32 v[122:123], v[118:119], v[116:117], v[122:123] op_sel:[1,1,0] op_sel_hi:[1,0,1] neg_lo:[1,0,0]
    v_pk_fma_f32 v[124:125], v[120:121], v[116:117], v[124:125] op_sel:[1,1,0] op_sel_hi:[1,0,1] neg_lo:[1,0,0]
    v_pk_fma_f32 v[126:127], v[98:99], v[96:97], v[126:127] op_sel:[1,1,0] op_sel_hi:[1,0,1] neg_lo:[1,0,0]
    v_pk_fma_f32 v[104:105], v[100:101], v[100:101], v[104:105] op_sel:[1,1,0] op_sel_hi:[1,0,1] neg_lo:[1,0,0]
    v_cvt_pk_bf16_f32 v46, v122, -v123
    v_cvt_pk_bf16_f32 v47, v124, -v125
    v_cvt_pk_bf16_f32 v48, v126, v127
    v_cvt_pk_bf16_f32 v49, v104, v105
    v_pk_mul_f32 v[126:127], v[100:101], v[86:87] op_sel:[0,0] op_sel_hi:[0,1]
    v_pk_mul_f32 v[128:129], v[100:101], v[90:91] op_sel:[0,0] op_sel_hi:[0,1]
    v_pk_mul_f32 v[130:131], v[100:101], v[94:95] op_sel:[0,0] op_sel_hi:[0,1]
    v_pk_mul_f32 v[106:107], v[104:105], v[98:99] op_sel:[0,0] op_sel_hi:[0,1]
    v_pk_fma_f32 v[126:127], v[100:101], v[86:87], v[126:127] op_sel:[1,1,0] op_sel_hi:[1,0,1] neg_lo:[1,0,0]
    v_pk_fma_f32 v[128:129], v[100:101], v[90:91], v[128:129] op_sel:[1,1,0] op_sel_hi:[1,0,1] neg_lo:[1,0,0]
    v_pk_fma_f32 v[130:131], v[100:101], v[94:95], v[130:131] op_sel:[1,1,0] op_sel_hi:[1,0,1] neg_lo:[1,0,0]
    v_pk_fma_f32 v[106:107], v[104:105], v[98:99], v[106:107] op_sel:[1,1,0] op_sel_hi:[1,0,1] neg_lo:[1,0,0]
    v_cvt_pk_bf16_f32 v50, v126, v127
    v_cvt_pk_bf16_f32 v51, v128, v129
    v_cvt_pk_bf16_f32 v52, v130, v131
    v_cvt_pk_bf16_f32 v53, v106, v107
    v_pk_mul_f32 v[126:127], v[102:103], v[86:87] op_sel:[0,0] op_sel_hi:[0,1]
    v_pk_mul_f32 v[128:129], v[102:103], v[90:91] op_sel:[0,0] op_sel_hi:[0,1]
    v_pk_mul_f32 v[130:131], v[102:103], v[94:95] op_sel:[0,0] op_sel_hi:[0,1]
    v_pk_mul_f32 v[108:109], v[104:105], v[100:101] op_sel:[0,0] op_sel_hi:[0,1]
    v_pk_fma_f32 v[126:127], v[102:103], v[86:87], v[126:127] op_sel:[1,1,0] op_sel_hi:[1,0,1] neg_lo:[1,0,0]
    v_pk_fma_f32 v[128:129], v[102:103], v[90:91], v[128:129] op_sel:[1,1,0] op_sel_hi:[1,0,1] neg_lo:[1,0,0]
    v_pk_fma_f32 v[130:131], v[102:103], v[94:95], v[130:131] op_sel:[1,1,0] op_sel_hi:[1,0,1] neg_lo:[1,0,0]
    v_pk_fma_f32 v[108:109], v[104:105], v[100:101], v[108:109] op_sel:[1,1,0] op_sel_hi:[1,0,1] neg_lo:[1,0,0]
    v_cvt_pk_bf16_f32 v54, v126, v127
    v_cvt_pk_bf16_f32 v55, v128, v129
    v_cvt_pk_bf16_f32 v56, v130, v131
    v_cvt_pk_bf16_f32 v57, v108, v109
    v_pk_mul_f32 v[110:111], v[104:105], v[102:103] op_sel:[0,0] op_sel_hi:[0,1]
    v_pk_mul_f32 v[112:113], v[104:105], v[104:105] op_sel:[0,0] op_sel_hi:[0,1]
    v_pk_mul_f32 v[126:127], v[104:105], v[90:91] op_sel:[0,0] op_sel_hi:[0,1]
    v_pk_mul_f32 v[128:129], v[106:107], v[90:91] op_sel:[0,0] op_sel_hi:[0,1]
    v_pk_fma_f32 v[110:111], v[104:105], v[102:103], v[110:111] op_sel:[1,1,0] op_sel_hi:[1,0,1] neg_lo:[1,0,0]
    v_pk_fma_f32 v[112:113], v[104:105], v[104:105], v[112:113] op_sel:[1,1,0] op_sel_hi:[1,0,1] neg_lo:[1,0,0]
    v_pk_fma_f32 v[126:127], v[104:105], v[90:91], v[126:127] op_sel:[1,1,0] op_sel_hi:[1,0,1] neg_lo:[1,0,0]
    v_pk_fma_f32 v[128:129], v[106:107], v[90:91], v[128:129] op_sel:[1,1,0] op_sel_hi:[1,0,1] neg_lo:[1,0,0]
    v_cvt_pk_bf16_f32 v58, v110, v111
    v_cvt_pk_bf16_f32 v59, v112, v113
    v_cvt_pk_bf16_f32 v60, v126, v127
    v_cvt_pk_bf16_f32 v61, v128, v129
    v_pk_mul_f32 v[126:127], v[108:109], v[90:91] op_sel:[0,0] op_sel_hi:[0,1]
    v_pk_mul_f32 v[128:129], v[110:111], v[90:91] op_sel:[0,0] op_sel_hi:[0,1]
    v_pk_mul_f32 v[130:131], v[112:113], v[98:99] op_sel:[0,0] op_sel_hi:[0,1]
    v_pk_mul_f32 v[132:133], v[112:113], v[100:101] op_sel:[0,0] op_sel_hi:[0,1]
    v_pk_fma_f32 v[126:127], v[108:109], v[90:91], v[126:127] op_sel:[1,1,0] op_sel_hi:[1,0,1] neg_lo:[1,0,0]
    v_pk_fma_f32 v[128:129], v[110:111], v[90:91], v[128:129] op_sel:[1,1,0] op_sel_hi:[1,0,1] neg_lo:[1,0,0]
    v_pk_fma_f32 v[130:131], v[112:113], v[98:99], v[130:131] op_sel:[1,1,0] op_sel_hi:[1,0,1] neg_lo:[1,0,0]
    v_pk_fma_f32 v[132:133], v[112:113], v[100:101], v[132:133] op_sel:[1,1,0] op_sel_hi:[1,0,1] neg_lo:[1,0,0]
    v_cvt_pk_bf16_f32 v62, v126, v127
    v_cvt_pk_bf16_f32 v63, v128, v129
    v_cvt_pk_bf16_f32 v189, v130, v131
    v_cvt_pk_bf16_f32 v190, v132, v133
    v_pk_mul_f32 v[126:127], v[112:113], v[102:103] op_sel:[0,0] op_sel_hi:[0,1]
    v_pk_mul_f32 v[128:129], v[112:113], v[104:105] op_sel:[0,0] op_sel_hi:[0,1]
    v_pk_mul_f32 v[130:131], v[112:113], v[106:107] op_sel:[0,0] op_sel_hi:[0,1]
    v_pk_fma_f32 v[126:127], v[112:113], v[102:103], v[126:127] op_sel:[1,1,0] op_sel_hi:[1,0,1] neg_lo:[1,0,0]
    v_pk_fma_f32 v[128:129], v[112:113], v[104:105], v[128:129] op_sel:[1,1,0] op_sel_hi:[1,0,1] neg_lo:[1,0,0]
    v_pk_fma_f32 v[130:131], v[112:113], v[106:107], v[130:131] op_sel:[1,1,0] op_sel_hi:[1,0,1] neg_lo:[1,0,0]
    v_cvt_pk_bf16_f32 v191, v126, v127
    v_cvt_pk_bf16_f32 v192, v128, v129
    v_cvt_pk_bf16_f32 v193, v130, v131
    v_pk_mul_f32 v[126:127], v[112:113], v[108:109] op_sel:[0,0] op_sel_hi:[0,1]
    v_pk_mul_f32 v[128:129], v[112:113], v[110:111] op_sel:[0,0] op_sel_hi:[0,1]
    v_pk_mul_f32 v[130:131], v[112:113], v[112:113] op_sel:[0,0] op_sel_hi:[0,1]
    v_pk_fma_f32 v[126:127], v[112:113], v[108:109], v[126:127] op_sel:[1,1,0] op_sel_hi:[1,0,1] neg_lo:[1,0,0]
    v_pk_fma_f32 v[128:129], v[112:113], v[110:111], v[128:129] op_sel:[1,1,0] op_sel_hi:[1,0,1] neg_lo:[1,0,0]
    v_pk_fma_f32 v[130:131], v[112:113], v[112:113], v[130:131] op_sel:[1,1,0] op_sel_hi:[1,0,1] neg_lo:[1,0,0]
    v_cvt_pk_bf16_f32 v194, v126, v127
    v_cvt_pk_bf16_f32 v195, v128, v129
    v_cvt_pk_bf16_f32 v196, v130, v131
    s_cmp_lg_u32 s11, 2
    s_cbranch_scc1 L_kL
    v_mov_b32 v197, v16
    v_mov_b32 v198, v17
    v_mov_b32 v199, v18
    v_mov_b32 v200, v19
    v_mov_b32 v201, v20
    v_mov_b32 v202, v21
    v_mov_b32 v203, v22
    v_mov_b32 v204, v23
    v_mov_b32 v205, v24
    v_mov_b32 v206, v25
    v_mov_b32 v207, v26
    v_mov_b32 v208, v27
    v_mov_b32 v209, v28
    v_mov_b32 v210, v29
    v_mov_b32 v211, v30
    v_mov_b32 v212, v31
    v_mov_b32 v213, v32
    v_mov_b32 v214, v33
    v_mov_b32 v215, v34
    v_mov_b32 v216, v35
    v_mov_b32 v217, v36
    v_mov_b32 v218, v37
    v_mov_b32 v219, v38
    v_mov_b32 v220, v39
    v_mov_b32 v221, v40
    v_mov_b32 v222, v41
    v_mov_b32 v223, v42
    v_mov_b32 v224, v43
    v_mov_b32 v225, v44
    v_mov_b32 v226, v45
    v_mov_b32 v227, v46
    v_mov_b32 v228, v47
    v_mov_b32 v229, v48
    v_mov_b32 v230, v49
    v_mov_b32 v231, v50
    v_mov_b32 v232, v51
    v_mov_b32 v233, v52
    v_mov_b32 v234, v53
    v_mov_b32 v235, v54
    v_mov_b32 v236, v55
    v_mov_b32 v237, v56
    v_mov_b32 v238, v57
    v_mov_b32 v239, v58
    v_mov_b32 v240, v59
    v_mov_b32 v241, v60
    v_mov_b32 v242, v61
    v_mov_b32 v243, v62
    v_mov_b32 v244, v63
    v_mov_b32 v245, v189
    v_mov_b32 v246, v190
    v_mov_b32 v247, v191
    v_mov_b32 v248, v192
    v_mov_b32 v249, v193
    v_mov_b32 v250, v194
    v_mov_b32 v251, v195
    v_mov_b32 v252, v196
    s_mov_b32 s11, 1
    s_branch L_kgen
L_kL:
    ds_write_addtid_b32 v16 offset:0
    ds_write_addtid_b32 v19 offset:288
    ds_write_addtid_b32 v22 offset:576
    ds_write_addtid_b32 v23 offset:864
    ds_write_addtid_b32 v26 offset:1152
    ds_write_addtid_b32 v27 offset:1440
    ds_write_addtid_b32 v30 offset:1728
    ds_write_addtid_b32 v31 offset:2016
    ds_write_addtid_b32 v34 offset:2304
    ds_write_addtid_b32 v35 offset:2592
    ds_write_addtid_b32 v38 offset:2880
    ds_write_addtid_b32 v39 offset:3168
    ds_write_addtid_b32 v42 offset:3456
    ds_write_addtid_b32 v43 offset:3744
    ds_write_addtid_b32 v46 offset:4032
    ds_write_addtid_b32 v47 offset:4320
    ds_read_b128 v[144:147], v188 offset:0
    ds_read_b128 v[148:151], v188 offset:64
    ds_read_b128 v[152:155], v188 offset:128
    ds_read_b128 v[156:159], v188 offset:192
    ds_write_addtid_b32 v143 offset:0
    ds_write_addtid_b32 v17 offset:288
    ds_write_addtid_b32 v18 offset:2304
    ds_write_addtid_b32 v20 offset:576
    ds_write_addtid_b32 v24 offset:864
    ds_write_addtid_b32 v25 offset:1152
    ds_write_addtid_b32 v28 offset:1440
    ds_write_addtid_b32 v29 offset:1728
    ds_write_addtid_b32 v32 offset:2016
    ds_write_addtid_b32 v36 offset:2592
    ds_write_addtid_b32 v37 offset:2880
    ds_write_addtid_b32 v40 offset:3168
    ds_write_addtid_b32 v41 offset:3456
    ds_write_addtid_b32 v44 offset:3744
    ds_write_addtid_b32 v45 offset:4032
    ds_write_addtid_b32 v48 offset:4320
    ds_read_b128 v[160:163], v188 offset:0
    ds_read_b128 v[164:167], v188 offset:64
    ds_read_b128 v[168:171], v188 offset:128
    ds_read_b128 v[172:175], v188 offset:192
    ds_write_addtid_b32 v21 offset:0
    ds_write_addtid_b32 v33 offset:1152
    ds_write_addtid_b32 v49 offset:2304
    ds_write_addtid_b32 v50 offset:288
    ds_write_addtid_b32 v51 offset:576
    ds_write_addtid_b32 v52 offset:864
    ds_write_addtid_b32 v53 offset:2880
    ds_write_addtid_b32 v54 offset:1440
    ds_write_addtid_b32 v55 offset:1728
    ds_write_addtid_b32 v56 offset:2016
    ds_write_addtid_b32 v57 offset:3456
    ds_write_addtid_b32 v58 offset:4032
    ds_write_addtid_b32 v60 offset:2592
    ds_write_addtid_b32 v61 offset:3168
    ds_write_addtid_b32 v62 offset:3744
    ds_write_addtid_b32 v63 offset:4320
    s_waitcnt lgkmcnt(15)
    v_mfma_f32_16x16x32_bf16 v[176:179], v[160:163], v[144:147], v[176:179]
    v_mfma_f32_16x16x32_bf16 v[176:179], v[164:167], v[148:151], v[176:179]
    v_mfma_f32_16x16x32_bf16 v[176:179], v[168:171], v[152:155], v[176:179]
    v_mfma_f32_16x16x32_bf16 v[176:179], v[172:175], v[156:159], v[176:179]
    ds_read_b128 v[160:163], v188 offset:0
    ds_read_b128 v[164:167], v188 offset:64
    ds_read_b128 v[168:171], v188 offset:128
    ds_read_b128 v[172:175], v188 offset:192
    ds_write_addtid_b32 v59 offset:0
    ds_write_addtid_b32 v189 offset:288
    ds_write_addtid_b32 v190 offset:576
    ds_write_addtid_b32 v191 offset:864
    ds_write_addtid_b32 v192 offset:1152
    ds_write_addtid_b32 v193 offset:1440
    ds_write_addtid_b32 v194 offset:1728
    ds_write_addtid_b32 v195 offset:2016
    ds_write_addtid_b32 v196 offset:2304
    s_waitcnt lgkmcnt(9)
    v_mfma_f32_16x16x32_bf16 v[180:183], v[160:163], v[144:147], v[180:183]
    v_mfma_f32_16x16x32_bf16 v[180:183], v[164:167], v[148:151], v[180:183]
    v_mfma_f32_16x16x32_bf16 v[180:183], v[168:171], v[152:155], v[180:183]
    v_mfma_f32_16x16x32_bf16 v[180:183], v[172:175], v[156:159], v[180:183]
    ds_read_b128 v[160:163], v188 offset:0
    ds_read_b128 v[164:167], v188 offset:64
    ds_read_b128 v[168:171], v188 offset:128
    ds_read_b128 v[172:175], v188 offset:192
    s_waitcnt lgkmcnt(0)
    v_mfma_f32_16x16x32_bf16 v[184:187], v[160:163], v[144:147], v[184:187]
    v_mfma_f32_16x16x32_bf16 v[184:187], v[164:167], v[148:151], v[184:187]
    v_mfma_f32_16x16x32_bf16 v[184:187], v[168:171], v[152:155], v[184:187]
    v_mfma_f32_16x16x32_bf16 v[184:187], v[172:175], v[156:159], v[184:187]
    s_sub_u32 s11, s11, 1
    s_cbranch_scc1 L_kend
    s_cmp_lg_u32 s11, 0
    s_cbranch_scc1 L_kgen
    v_mov_b32 v16, v197
    v_mov_b32 v17, v198
    v_mov_b32 v18, v199
    v_mov_b32 v19, v200
    v_mov_b32 v20, v201
    v_mov_b32 v21, v202
    v_mov_b32 v22, v203
    v_mov_b32 v23, v204
    v_mov_b32 v24, v205
    v_mov_b32 v25, v206
    v_mov_b32 v26, v207
    v_mov_b32 v27, v208
    v_mov_b32 v28, v209
    v_mov_b32 v29, v210
    v_mov_b32 v30, v211
    v_mov_b32 v31, v212
    v_mov_b32 v32, v213
    v_mov_b32 v33, v214
    v_mov_b32 v34, v215
    v_mov_b32 v35, v216
    v_mov_b32 v36, v217
    v_mov_b32 v37, v218
    v_mov_b32 v38, v219
    v_mov_b32 v39, v220
    v_mov_b32 v40, v221
    v_mov_b32 v41, v222
    v_mov_b32 v42, v223
    v_mov_b32 v43, v224
    v_mov_b32 v44, v225
    v_mov_b32 v45, v226
    v_mov_b32 v46, v227
    v_mov_b32 v47, v228
    v_mov_b32 v48, v229
    v_mov_b32 v49, v230
    v_mov_b32 v50, v231
    v_mov_b32 v51, v232
    v_mov_b32 v52, v233
    v_mov_b32 v53, v234
    v_mov_b32 v54, v235
    v_mov_b32 v55, v236
    v_mov_b32 v56, v237
    v_mov_b32 v57, v238
    v_mov_b32 v58, v239
    v_mov_b32 v59, v240
    v_mov_b32 v60, v241
    v_mov_b32 v61, v242
    v_mov_b32 v62, v243
    v_mov_b32 v63, v244
    v_mov_b32 v189, v245
    v_mov_b32 v190, v246
    v_mov_b32 v191, v247
    v_mov_b32 v192, v248
    v_mov_b32 v193, v249
    v_mov_b32 v194, v250
    v_mov_b32 v195, v251
    v_mov_b32 v196, v252
    s_branch L_kL
L_kend:
    s_nop 7
    s_waitcnt vmcnt(0)
    s_setprio 3
    v_and_b32 v16, 15, v0
    v_lshrrev_b32 v17, 4, v0
    s_add_u32 s8, s95, 4624
    v_lshrrev_b32 v18, 1, v17
    v_lshlrev_b32 v18, 7, v18
    v_and_b32 v19, 1, v17
    v_lshl_add_u32 v18, v19, 2, v18
    v_lshl_add_u32 v18, v16, 3, v18
    v_lshl_add_u32 v18, v18, 2, s8
    v_lshlrev_b32 v19, 2, v16
    v_lshlrev_b32 v20, 1, v16
    v_cmp_gt_u32 vcc, 2, v17
    s_nop 1
    v_cndmask_b32 v19, v20, v19, vcc
    v_lshl_add_u32 v19, v17, 6, v19
    v_lshl_add_u32 v19, v19, 2, s8
    v_mov_b32 v20, 128
    v_cndmask_b32 v20, v20, 8, vcc
    v_add_u32 v20, v19, v20
    v_lshl_add_u32 v21, v17, 6, v16
    v_lshl_add_u32 v21, v21, 2, s8
    v_lshlrev_b32 v22, 4, v0
    v_add_u32 v22, 8256, v22
    v_mov_b32 v23, 4096
    v_cmp_gt_u32 vcc, 14, v0
    s_nop 1
    v_cndmask_b32 v22, v23, v22, vcc
    v_mov_b32 v23, 4608
    v_cmp_eq_u32 vcc, 14, v0
    s_nop 1
    v_cndmask_b32 v22, v22, v23, vcc
    v_add_u32 v22, s95, v22
    v_mov_b32 v24, 0
    v_mov_b32 v25, 0
    v_mov_b32 v26, 0
    v_mov_b32 v27, 0
    ds_write_b128 v22, v[24:27]
    ds_write_b128 v18, v[176:179]
    ds_write_b64 v19, v[180:181] offset:1024
    ds_write_b64 v20, v[182:183] offset:1024
    ds_write_b32 v21, v184 offset:2048
    ds_write_b32 v21, v185 offset:2112
    ds_write_b32 v21, v186 offset:2176
    ds_write_b32 v21, v187 offset:2240
    v_lshl_add_u32 v18, v0, 4, s8
    v_lshl_add_u32 v19, v0, 3, s8
    v_subrev_u32 v20, 4, v18
    v_subrev_u32 v21, 4, v19
    v_cmp_eq_u32 vcc, 0, v0
    s_nop 1
    v_cndmask_b32 v21, v19, v21, vcc
    ds_read_b128 v[28:31], v18
    ds_read_b32 v32, v20
    ds_read_b64 v[34:35], v19 offset:1024
    ds_read_b32 v36, v19 offset:1032
    ds_read_b32 v37, v21 offset:1024
    ds_read_b64 v[38:39], v19 offset:1536
    ds_read_b32 v40, v19 offset:1544
    ds_read_b64 v[42:43], v19 offset:2048
    ds_read_b32 v44, v19 offset:2056
    v_lshlrev_b32 v22, 3, v0
    v_sub_u32 v22, s95, v22
    v_lshlrev_b32 v23, 4, v0
    v_sub_u32 v23, s95, v23
    v_lshlrev_b32 v24, 5, v0
    v_sub_u32 v24, s95, v24
    v_add_u32 v22, 3576, v22
    v_add_u32 v23, 3056, v23
    v_add_u32 v24, 2016, v24
    v_cndmask_b32 v33, 0, v83, vcc
    s_waitcnt lgkmcnt(7)
    v_add_f32 v28, v28, v33
    v_cvt_pk_bf16_f32 v48, v31, v30
    v_cvt_pk_bf16_f32 v49, v29, v28
    v_cvt_pk_bf16_f32 v50, v30, v29
    v_cvt_pk_bf16_f32 v51, v28, v32
    ds_write_b64 v22, v[48:49] offset:512
    ds_write_b64 v22, v[50:51] offset:4672
    s_waitcnt lgkmcnt(6)
    v_cvt_pk_bf16_f32 v52, v36, v35
    v_cvt_pk_bf16_f32 v53, v34, v34
    v_cvt_pk_bf16_f32 v54, v35, v34
    v_cvt_pk_bf16_f32 v55, v34, v37
    ds_write_b64 v22, v[52:53]
    ds_write_b64 v22, v[54:55] offset:4160
    s_waitcnt lgkmcnt(6)
    v_cvt_pk_bf16_f32 v56, v40, v40
    v_cvt_pk_bf16_f32 v57, v39, v39
    v_cvt_pk_bf16_f32 v58, v39, v38
    v_cvt_pk_bf16_f32 v59, v38, v38
    v_cvt_pk_bf16_f32 v60, v40, v39
    v_cvt_pk_bf16_f32 v61, v39, v39
    v_cvt_pk_bf16_f32 v62, v38, v38
    v_cvt_pk_bf16_f32 v63, v38, v38
    ds_write_b128 v23, v[56:59]
    ds_write_b128 v23, v[60:63] offset:4160
    s_waitcnt lgkmcnt(6)
    v_cvt_pk_bf16_f32 v64, v44, v44
    v_cvt_pk_bf16_f32 v65, v44, v44
    v_cvt_pk_bf16_f32 v66, v43, v43
    v_cvt_pk_bf16_f32 v67, v43, v43
    v_cvt_pk_bf16_f32 v68, v43, v43
    v_cvt_pk_bf16_f32 v69, v43, v42
    v_cvt_pk_bf16_f32 v70, v42, v42
    v_cvt_pk_bf16_f32 v71, v42, v42
    v_cvt_pk_bf16_f32 v72, v44, v44
    v_cvt_pk_bf16_f32 v73, v44, v43
    v_cvt_pk_bf16_f32 v74, v43, v43
    v_cvt_pk_bf16_f32 v75, v43, v43
    v_cvt_pk_bf16_f32 v76, v43, v43
    v_cvt_pk_bf16_f32 v77, v42, v42
    v_cvt_pk_bf16_f32 v78, v42, v42
    v_cvt_pk_bf16_f32 v79, v42, v42
    ds_write_b128 v24, v[64:67]
    ds_write_b128 v24, v[68:71] offset:16
    ds_write_b128 v24, v[72:75] offset:4160
    ds_write_b128 v24, v[76:79] offset:4176
    v_and_b32 v12, 15, v0
    v_lshrrev_b32 v13, 4, v0
    v_lshlrev_b32 v13, 1, v13
    v_sub_u32 v12, v12, v13
    v_lshlrev_b32 v12, 4, v12
    s_add_u32 s9, s95, 8352
    v_add_u32 v10, s9, v12
    v_lshrrev_b32 v12, 1, v0
    v_lshlrev_b32 v12, 2, v12
    v_and_b32 v13, 1, v0
    v_mul_u32_u24 v13, 4160, v13
    v_add_u32 v12, v12, v13
    s_add_u32 s9, s95, 7356
    v_sub_u32 v11, s9, v12
    v_subrev_u32 v12, 1024, v11
    v_subrev_u32 v13, 2048, v11
    v_subrev_u32 v14, 3072, v11
    ds_read2_b32 v[80:81], v11 offset0:224 offset1:225
    ds_read2_b32 v[82:83], v11 offset0:226 offset1:227
    ds_read2_b32 v[84:85], v11 offset0:160 offset1:161
    ds_read2_b32 v[86:87], v11 offset0:162 offset1:163
    ds_read2_b32 v[88:89], v11 offset0:96 offset1:97
    ds_read2_b32 v[90:91], v11 offset0:98 offset1:99
    ds_read2_b32 v[92:93], v11 offset0:32 offset1:33
    ds_read2_b32 v[94:95], v11 offset0:34 offset1:35
    ds_read2_b32 v[96:97], v12 offset0:224 offset1:225
    ds_read2_b32 v[98:99], v12 offset0:226 offset1:227
    ds_read2_b32 v[100:101], v12 offset0:160 offset1:161
    ds_read2_b32 v[102:103], v12 offset0:162 offset1:163
    ds_read2_b32 v[104:105], v12 offset0:96 offset1:97
    ds_read2_b32 v[106:107], v12 offset0:98 offset1:99
    ds_read2_b32 v[108:109], v12 offset0:32 offset1:33
    ds_read2_b32 v[110:111], v12 offset0:34 offset1:35
    v_and_b32 v4, 15, v0
    v_lshlrev_b32 v4, 4, v4
    v_lshrrev_b32 v5, 5, v0
    v_lshl_add_u32 v4, v5, 11, v4
    v_bfe_u32 v5, v0, 4, 1
    v_lshl_add_u32 v4, v5, 8, v4
    v_and_b32 v5, 24, v0
    v_lshlrev_b32 v5, 3, v5
    v_and_b32 v6, 7, v0
    v_add_u32 v5, v5, v6
    s_lshl_b32 s8, s4, 3
    v_add_lshl_u32 v5, v5, s8, 7
    v_mov_b32 v6, 47968
    v_mov_b32 v8, 47992
    s_mov_b32 s12, 0x200000
L_lw5:
    ds_read_b32 v9, v8
    s_waitcnt lgkmcnt(0)
    v_readfirstlane_b32 s8, v9
    s_nop 0
    s_cmp_ge_u32 s8, 1
    s_cbranch_scc1 L_lwok5
    s_sleep 1
    s_sub_u32 s12, s12, 1
    s_cmp_lg_u32 s12, 0
    s_cbranch_scc1 L_lw5
L_lwok5:
    v_add_u32 v8, s95, v2
    v_lshlrev_b32 v9, 5, v0
    ds_read_b128 v[16:19], v9 offset:37728
    ds_read_b128 v[20:23], v9 offset:37744
    ds_read_b128 v[208:211], v8 offset:8480
    ds_read_b128 v[24:27], v9 offset:39776
    ds_read_b128 v[28:31], v9 offset:39792
    ds_read_b128 v[212:215], v8 offset:9504
    ds_read_b128 v[32:35], v9 offset:41824
    ds_read_b128 v[36:39], v9 offset:41840
    ds_read_b128 v[216:219], v8 offset:10528
    ds_read_b128 v[40:43], v9 offset:43872
    ds_read_b128 v[44:47], v9 offset:43888
    ds_read_b128 v[220:223], v8 offset:11552
    s_waitcnt lgkmcnt(9)
    v_lshlrev_b32 v48, 16, v16
    v_and_b32 v16, s13, v16
    ds_read2_b32 v[112:113], v13 offset0:224 offset1:225
    v_lshlrev_b32 v49, 16, v17
    v_and_b32 v17, s13, v17
    v_lshlrev_b32 v50, 16, v18
    ds_read2_b32 v[114:115], v13 offset0:226 offset1:227
    v_and_b32 v18, s13, v18
    v_lshlrev_b32 v51, 16, v19
    v_and_b32 v19, s13, v19
    ds_read2_b32 v[116:117], v13 offset0:160 offset1:161
    v_lshlrev_b32 v52, 16, v20
    v_and_b32 v20, s13, v20
    v_lshlrev_b32 v53, 16, v21
    ds_read2_b32 v[118:119], v13 offset0:162 offset1:163
    v_and_b32 v21, s13, v21
    v_lshlrev_b32 v54, 16, v22
    v_and_b32 v22, s13, v22
    ds_read2_b32 v[120:121], v13 offset0:96 offset1:97
    v_lshlrev_b32 v55, 16, v23
    v_and_b32 v23, s13, v23
    v_lshlrev_b32 v224, 16, v208
    ds_read2_b32 v[122:123], v13 offset0:98 offset1:99
    v_and_b32 v225, s13, v208
    v_lshlrev_b32 v226, 16, v209
    v_and_b32 v227, s13, v209
    ds_read2_b32 v[124:125], v13 offset0:32 offset1:33
    v_lshlrev_b32 v228, 16, v210
    v_and_b32 v229, s13, v210
    v_lshlrev_b32 v230, 16, v211
    ds_read2_b32 v[126:127], v13 offset0:34 offset1:35
    v_and_b32 v231, s13, v211
    v_fmac_f32 v48, v224, v16
    v_fmac_f32 v49, v225, v17
    ds_read2_b32 v[128:129], v14 offset0:224 offset1:225
    v_fmac_f32 v50, v226, v18
    v_fmac_f32 v51, v227, v19
    v_fmac_f32 v52, v228, v20
    ds_read2_b32 v[130:131], v14 offset0:226 offset1:227
    v_fmac_f32 v53, v229, v21
    v_fmac_f32 v54, v230, v22
    v_fmac_f32 v55, v231, v23
    ds_read2_b32 v[132:133], v14 offset0:160 offset1:161
    v_cvt_pk_bf16_f32 v16, v48, v49
    v_cvt_pk_bf16_f32 v17, v50, v51
    v_cvt_pk_bf16_f32 v18, v52, v53
    ds_read2_b32 v[134:135], v14 offset0:162 offset1:163
    v_cvt_pk_bf16_f32 v19, v54, v55
    ds_write_b128 v8, v[16:19] offset:8480
    s_waitcnt lgkmcnt(15)
    ds_read2_b32 v[136:137], v14 offset0:96 offset1:97
    v_lshlrev_b32 v56, 16, v24
    v_and_b32 v24, s13, v24
    v_lshlrev_b32 v57, 16, v25
    ds_read2_b32 v[138:139], v14 offset0:98 offset1:99
    v_and_b32 v25, s13, v25
    v_lshlrev_b32 v58, 16, v26
    v_and_b32 v26, s13, v26
    ds_read2_b32 v[140:141], v14 offset0:32 offset1:33
    v_lshlrev_b32 v59, 16, v27
    v_and_b32 v27, s13, v27
    v_lshlrev_b32 v60, 16, v28
    ds_read2_b32 v[142:143], v14 offset0:34 offset1:35
    v_and_b32 v28, s13, v28
    v_lshlrev_b32 v61, 16, v29
    v_and_b32 v29, s13, v29
    ds_read2_b32 v[144:145], v11 offset0:192 offset1:193
    v_lshlrev_b32 v62, 16, v30
    v_and_b32 v30, s13, v30
    v_lshlrev_b32 v63, 16, v31
    ds_read2_b32 v[146:147], v11 offset0:194 offset1:195
    v_and_b32 v31, s13, v31
    v_lshlrev_b32 v224, 16, v212
    v_and_b32 v225, s13, v212
    ds_read2_b32 v[148:149], v11 offset0:128 offset1:129
    v_lshlrev_b32 v226, 16, v213
    v_and_b32 v227, s13, v213
    v_lshlrev_b32 v228, 16, v214
    ds_read2_b32 v[150:151], v11 offset0:130 offset1:131
    v_and_b32 v229, s13, v214
    v_lshlrev_b32 v230, 16, v215
    v_and_b32 v231, s13, v215
    ds_read2_b32 v[152:153], v11 offset0:64 offset1:65
    v_fmac_f32 v56, v224, v24
    v_fmac_f32 v57, v225, v25
    v_fmac_f32 v58, v226, v26
    ds_read2_b32 v[154:155], v11 offset0:66 offset1:67
    v_fmac_f32 v59, v227, v27
    v_fmac_f32 v60, v228, v28
    v_fmac_f32 v61, v229, v29
    ds_read2_b32 v[156:157], v11 offset0:0 offset1:1
    v_fmac_f32 v62, v230, v30
    v_fmac_f32 v63, v231, v31
    v_cvt_pk_bf16_f32 v24, v56, v57
    ds_read2_b32 v[158:159], v11 offset0:2 offset1:3
    v_cvt_pk_bf16_f32 v25, v58, v59
    v_cvt_pk_bf16_f32 v26, v60, v61
    v_cvt_pk_bf16_f32 v27, v62, v63
    ds_read2_b32 v[160:161], v12 offset0:192 offset1:193
    ds_write_b128 v8, v[24:27] offset:9504
    v_lshlrev_b32 v64, 16, v32
    ds_read2_b32 v[162:163], v12 offset0:194 offset1:195
    v_and_b32 v32, s13, v32
    v_lshlrev_b32 v65, 16, v33
    v_and_b32 v33, s13, v33
    ds_read2_b32 v[164:165], v12 offset0:128 offset1:129
    v_lshlrev_b32 v66, 16, v34
    v_and_b32 v34, s13, v34
    v_lshlrev_b32 v67, 16, v35
    ds_read2_b32 v[166:167], v12 offset0:130 offset1:131
    v_and_b32 v35, s13, v35
    v_lshlrev_b32 v68, 16, v36
    v_and_b32 v36, s13, v36
    ds_read2_b32 v[168:169], v12 offset0:64 offset1:65
    v_lshlrev_b32 v69, 16, v37
    v_and_b32 v37, s13, v37
    v_lshlrev_b32 v70, 16, v38
    ds_read2_b32 v[170:171], v12 offset0:66 offset1:67
    v_and_b32 v38, s13, v38
    v_lshlrev_b32 v71, 16, v39
    v_and_b32 v39, s13, v39
    ds_read2_b32 v[172:173], v12 offset0:0 offset1:1
    v_lshlrev_b32 v224, 16, v216
    v_and_b32 v225, s13, v216
    v_lshlrev_b32 v226, 16, v217
    ds_read2_b32 v[174:175], v12 offset0:2 offset1:3
    v_and_b32 v227, s13, v217
    v_lshlrev_b32 v228, 16, v218
    v_and_b32 v229, s13, v218
    ds_read2_b32 v[176:177], v13 offset0:192 offset1:193
    v_lshlrev_b32 v230, 16, v219
    v_and_b32 v231, s13, v219
    v_fmac_f32 v64, v224, v32
    ds_read2_b32 v[178:179], v13 offset0:194 offset1:195
    v_fmac_f32 v65, v225, v33
    v_fmac_f32 v66, v226, v34
    v_fmac_f32 v67, v227, v35
    ds_read2_b32 v[180:181], v13 offset0:128 offset1:129
    v_fmac_f32 v68, v228, v36
    v_fmac_f32 v69, v229, v37
    v_fmac_f32 v70, v230, v38
    ds_read2_b32 v[182:183], v13 offset0:130 offset1:131
    v_fmac_f32 v71, v231, v39
    v_cvt_pk_bf16_f32 v32, v64, v65
    v_cvt_pk_bf16_f32 v33, v66, v67
    ds_read2_b32 v[184:185], v13 offset0:64 offset1:65
    v_cvt_pk_bf16_f32 v34, v68, v69
    v_cvt_pk_bf16_f32 v35, v70, v71
    ds_write_b128 v8, v[32:35] offset:10528
    ds_read2_b32 v[186:187], v13 offset0:66 offset1:67
    s_waitcnt lgkmcnt(15)
    v_lshlrev_b32 v72, 16, v40
    v_and_b32 v40, s13, v40
    ds_read2_b32 v[188:189], v13 offset0:0 offset1:1
    v_lshlrev_b32 v73, 16, v41
    v_and_b32 v41, s13, v41
    v_lshlrev_b32 v74, 16, v42
    ds_read2_b32 v[190:191], v13 offset0:2 offset1:3
    v_and_b32 v42, s13, v42
    v_lshlrev_b32 v75, 16, v43
    v_and_b32 v43, s13, v43
    ds_read2_b32 v[192:193], v14 offset0:192 offset1:193
    v_lshlrev_b32 v76, 16, v44
    v_and_b32 v44, s13, v44
    v_lshlrev_b32 v77, 16, v45
    ds_read2_b32 v[194:195], v14 offset0:194 offset1:195
    v_and_b32 v45, s13, v45
    v_lshlrev_b32 v78, 16, v46
    v_and_b32 v46, s13, v46
    ds_read2_b32 v[196:197], v14 offset0:128 offset1:129
    v_lshlrev_b32 v79, 16, v47
    v_and_b32 v47, s13, v47
    v_lshlrev_b32 v224, 16, v220
    ds_read2_b32 v[198:199], v14 offset0:130 offset1:131
    v_and_b32 v225, s13, v220
    v_lshlrev_b32 v226, 16, v221
    v_and_b32 v227, s13, v221
    ds_read2_b32 v[200:201], v14 offset0:64 offset1:65
    v_lshlrev_b32 v228, 16, v222
    v_and_b32 v229, s13, v222
    v_lshlrev_b32 v230, 16, v223
    ds_read2_b32 v[202:203], v14 offset0:66 offset1:67
    v_and_b32 v231, s13, v223
    v_fmac_f32 v72, v224, v40
    v_fmac_f32 v73, v225, v41
    ds_read2_b32 v[204:205], v14 offset0:0 offset1:1
    v_fmac_f32 v74, v226, v42
    v_fmac_f32 v75, v227, v43
    v_fmac_f32 v76, v228, v44
    ds_read2_b32 v[206:207], v14 offset0:2 offset1:3
    v_fmac_f32 v77, v229, v45
    v_fmac_f32 v78, v230, v46
    v_fmac_f32 v79, v231, v47
    v_cvt_pk_bf16_f32 v40, v72, v73
    v_cvt_pk_bf16_f32 v41, v74, v75
    v_cvt_pk_bf16_f32 v42, v76, v77
    v_cvt_pk_bf16_f32 v43, v78, v79
    ds_write_b128 v8, v[40:43] offset:11552
    v_mov_b32 v8, 48012
    v_mov_b32 v9, 1
    s_mov_b64 exec, 1
    ds_add_u32 v8, v9
    s_mov_b64 exec, -1
    s_setprio 0
    ds_read_b128 v[208:211], v10 offset:128
    ds_read_b128 v[212:215], v10 offset:3968
    ds_read_b128 v[216:219], v10 offset:384
    ds_read_b128 v[220:223], v10 offset:3712
    ds_read_b128 v[224:227], v10 offset:640
    ds_read_b128 v[228:231], v10 offset:3456
    ds_read2_b32 v[8:9], v6 offset0:0 offset1:7
    ds_read_b128 v[232:235], v10 offset:896
    ds_read_b128 v[236:239], v10 offset:3200
    s_waitcnt lgkmcnt(8)
    v_mfma_f32_16x16x32_bf16 v[16:19], v[80:83], v[208:211], 0
    v_mfma_f32_16x16x32_bf16 v[20:23], v[84:87], v[208:211], 0
    v_mfma_f32_16x16x32_bf16 v[24:27], v[88:91], v[208:211], 0
    v_mfma_f32_16x16x32_bf16 v[28:31], v[92:95], v[208:211], 0
    v_mfma_f32_16x16x32_bf16 v[32:35], v[96:99], v[208:211], 0
    v_mfma_f32_16x16x32_bf16 v[36:39], v[100:103], v[208:211], 0
    v_mfma_f32_16x16x32_bf16 v[40:43], v[104:107], v[208:211], 0
    v_mfma_f32_16x16x32_bf16 v[44:47], v[108:111], v[208:211], 0
    v_mfma_f32_16x16x32_bf16 v[48:51], v[112:115], v[208:211], 0
    v_mfma_f32_16x16x32_bf16 v[52:55], v[116:119], v[208:211], 0
    v_mfma_f32_16x16x32_bf16 v[56:59], v[120:123], v[208:211], 0
    v_mfma_f32_16x16x32_bf16 v[60:63], v[124:127], v[208:211], 0
    v_mfma_f32_16x16x32_bf16 v[64:67], v[128:131], v[208:211], 0
    v_mfma_f32_16x16x32_bf16 v[68:71], v[132:135], v[208:211], 0
    v_mfma_f32_16x16x32_bf16 v[72:75], v[136:139], v[208:211], 0
    v_mfma_f32_16x16x32_bf16 v[76:79], v[140:143], v[208:211], 0
    s_waitcnt lgkmcnt(7)
    v_mfma_f32_16x16x32_bf16 v[76:79], v[80:83], v[212:215], v[76:79]
    s_waitcnt lgkmcnt(2)
    v_cmp_le_u32 vcc, 4, v9
    s_cbranch_vccz L_nlp
    s_setprio 3
L_nlp:
    v_cmp_ne_u32 vcc, v8, v9
    s_cbranch_vccnz L_pz2
L_np2:
    ds_read2_b32 v[8:9], v6 offset0:0 offset1:7
    ds_read_b128 v[208:211], v10 offset:1152
    ds_read_b128 v[212:215], v10 offset:2944
    v_mfma_f32_16x16x32_bf16 v[20:23], v[80:83], v[216:219], v[20:23]
    v_mfma_f32_16x16x32_bf16 v[24:27], v[84:87], v[216:219], v[24:27]
    v_mfma_f32_16x16x32_bf16 v[28:31], v[88:91], v[216:219], v[28:31]
    v_mfma_f32_16x16x32_bf16 v[32:35], v[92:95], v[216:219], v[32:35]
    v_mfma_f32_16x16x32_bf16 v[36:39], v[96:99], v[216:219], v[36:39]
    v_mfma_f32_16x16x32_bf16 v[40:43], v[100:103], v[216:219], v[40:43]
    v_mfma_f32_16x16x32_bf16 v[44:47], v[104:107], v[216:219], v[44:47]
    v_mfma_f32_16x16x32_bf16 v[48:51], v[108:111], v[216:219], v[48:51]
    v_mfma_f32_16x16x32_bf16 v[52:55], v[112:115], v[216:219], v[52:55]
    v_mfma_f32_16x16x32_bf16 v[56:59], v[116:119], v[216:219], v[56:59]
    v_mfma_f32_16x16x32_bf16 v[60:63], v[120:123], v[216:219], v[60:63]
    v_mfma_f32_16x16x32_bf16 v[64:67], v[124:127], v[216:219], v[64:67]
    v_mfma_f32_16x16x32_bf16 v[68:71], v[128:131], v[216:219], v[68:71]
    v_mfma_f32_16x16x32_bf16 v[72:75], v[132:135], v[216:219], v[72:75]
    v_mfma_f32_16x16x32_bf16 v[76:79], v[136:139], v[216:219], v[76:79]
    v_mfma_f32_16x16x32_bf16 v[72:75], v[80:83], v[220:223], v[72:75]
    v_mfma_f32_16x16x32_bf16 v[76:79], v[84:87], v[220:223], v[76:79]
    s_waitcnt lgkmcnt(2)
    v_cmp_ne_u32 vcc, v8, v9
    s_cbranch_vccnz L_pz4
L_np4:
    ds_read2_b32 v[8:9], v6 offset0:0 offset1:7
    ds_read_b128 v[216:219], v10 offset:1408
    ds_read_b128 v[220:223], v10 offset:2688
    v_mfma_f32_16x16x32_bf16 v[24:27], v[80:83], v[224:227], v[24:27]
    v_mfma_f32_16x16x32_bf16 v[28:31], v[84:87], v[224:227], v[28:31]
    v_mfma_f32_16x16x32_bf16 v[32:35], v[88:91], v[224:227], v[32:35]
    v_mfma_f32_16x16x32_bf16 v[36:39], v[92:95], v[224:227], v[36:39]
    v_mfma_f32_16x16x32_bf16 v[40:43], v[96:99], v[224:227], v[40:43]
    v_mfma_f32_16x16x32_bf16 v[44:47], v[100:103], v[224:227], v[44:47]
    v_mfma_f32_16x16x32_bf16 v[48:51], v[104:107], v[224:227], v[48:51]
    v_mfma_f32_16x16x32_bf16 v[52:55], v[108:111], v[224:227], v[52:55]
    v_mfma_f32_16x16x32_bf16 v[56:59], v[112:115], v[224:227], v[56:59]
    v_mfma_f32_16x16x32_bf16 v[60:63], v[116:119], v[224:227], v[60:63]
    v_mfma_f32_16x16x32_bf16 v[64:67], v[120:123], v[224:227], v[64:67]
    v_mfma_f32_16x16x32_bf16 v[68:71], v[124:127], v[224:227], v[68:71]
    v_mfma_f32_16x16x32_bf16 v[72:75], v[128:131], v[224:227], v[72:75]
    v_mfma_f32_16x16x32_bf16 v[76:79], v[132:135], v[224:227], v[76:79]
    v_mfma_f32_16x16x32_bf16 v[68:71], v[80:83], v[228:231], v[68:71]
    v_mfma_f32_16x16x32_bf16 v[72:75], v[84:87], v[228:231], v[72:75]
    v_mfma_f32_16x16x32_bf16 v[76:79], v[88:91], v[228:231], v[76:79]
    s_waitcnt lgkmcnt(2)
    v_cmp_ne_u32 vcc, v8, v9
    s_cbranch_vccnz L_pz6
L_np6:
    ds_read2_b32 v[8:9], v6 offset0:0 offset1:7
    ds_read_b128 v[224:227], v10 offset:1664
    ds_read_b128 v[228:231], v10 offset:2432
    v_mfma_f32_16x16x32_bf16 v[28:31], v[80:83], v[232:235], v[28:31]
    v_mfma_f32_16x16x32_bf16 v[32:35], v[84:87], v[232:235], v[32:35]
    v_mfma_f32_16x16x32_bf16 v[36:39], v[88:91], v[232:235], v[36:39]
    v_mfma_f32_16x16x32_bf16 v[40:43], v[92:95], v[232:235], v[40:43]
    v_mfma_f32_16x16x32_bf16 v[44:47], v[96:99], v[232:235], v[44:47]
    v_mfma_f32_16x16x32_bf16 v[48:51], v[100:103], v[232:235], v[48:51]
    v_mfma_f32_16x16x32_bf16 v[52:55], v[104:107], v[232:235], v[52:55]
    v_mfma_f32_16x16x32_bf16 v[56:59], v[108:111], v[232:235], v[56:59]
    v_mfma_f32_16x16x32_bf16 v[60:63], v[112:115], v[232:235], v[60:63]
    v_mfma_f32_16x16x32_bf16 v[64:67], v[116:119], v[232:235], v[64:67]
    v_mfma_f32_16x16x32_bf16 v[68:71], v[120:123], v[232:235], v[68:71]
    v_mfma_f32_16x16x32_bf16 v[72:75], v[124:127], v[232:235], v[72:75]
    v_mfma_f32_16x16x32_bf16 v[76:79], v[128:131], v[232:235], v[76:79]
    v_mfma_f32_16x16x32_bf16 v[64:67], v[80:83], v[236:239], v[64:67]
    v_mfma_f32_16x16x32_bf16 v[68:71], v[84:87], v[236:239], v[68:71]
    v_mfma_f32_16x16x32_bf16 v[72:75], v[88:91], v[236:239], v[72:75]
    v_mfma_f32_16x16x32_bf16 v[76:79], v[92:95], v[236:239], v[76:79]
    s_waitcnt lgkmcnt(2)
    v_cmp_ne_u32 vcc, v8, v9
    s_cbranch_vccnz L_pz8
L_np8:
    ds_read2_b32 v[8:9], v6 offset0:0 offset1:7
    ds_read_b128 v[232:235], v10 offset:1920
    ds_read_b128 v[236:239], v10 offset:2176
    v_mfma_f32_16x16x32_bf16 v[32:35], v[80:83], v[208:211], v[32:35]
    v_mfma_f32_16x16x32_bf16 v[36:39], v[84:87], v[208:211], v[36:39]
    v_mfma_f32_16x16x32_bf16 v[40:43], v[88:91], v[208:211], v[40:43]
    v_mfma_f32_16x16x32_bf16 v[44:47], v[92:95], v[208:211], v[44:47]
    v_mfma_f32_16x16x32_bf16 v[48:51], v[96:99], v[208:211], v[48:51]
    v_mfma_f32_16x16x32_bf16 v[52:55], v[100:103], v[208:211], v[52:55]
    v_mfma_f32_16x16x32_bf16 v[56:59], v[104:107], v[208:211], v[56:59]
    v_mfma_f32_16x16x32_bf16 v[60:63], v[108:111], v[208:211], v[60:63]
    v_mfma_f32_16x16x32_bf16 v[64:67], v[112:115], v[208:211], v[64:67]
    v_mfma_f32_16x16x32_bf16 v[68:71], v[116:119], v[208:211], v[68:71]
    v_mfma_f32_16x16x32_bf16 v[72:75], v[120:123], v[208:211], v[72:75]
    v_mfma_f32_16x16x32_bf16 v[76:79], v[124:127], v[208:211], v[76:79]
    v_mfma_f32_16x16x32_bf16 v[60:63], v[80:83], v[212:215], v[60:63]
    v_mfma_f32_16x16x32_bf16 v[64:67], v[84:87], v[212:215], v[64:67]
    v_mfma_f32_16x16x32_bf16 v[68:71], v[88:91], v[212:215], v[68:71]
    v_mfma_f32_16x16x32_bf16 v[72:75], v[92:95], v[212:215], v[72:75]
    v_mfma_f32_16x16x32_bf16 v[76:79], v[96:99], v[212:215], v[76:79]
    s_waitcnt lgkmcnt(2)
    v_cmp_ne_u32 vcc, v8, v9
    s_cbranch_vccnz L_pz10
L_np10:
    ds_read2_b32 v[8:9], v6 offset0:0 offset1:7
    ds_read_b128 v[208:211], v10 offset:0
    ds_read_b128 v[212:215], v10 offset:3840
    v_mfma_f32_16x16x32_bf16 v[36:39], v[80:83], v[216:219], v[36:39]
    v_mfma_f32_16x16x32_bf16 v[40:43], v[84:87], v[216:219], v[40:43]
    v_mfma_f32_16x16x32_bf16 v[44:47], v[88:91], v[216:219], v[44:47]
    v_mfma_f32_16x16x32_bf16 v[48:51], v[92:95], v[216:219], v[48:51]
    v_mfma_f32_16x16x32_bf16 v[52:55], v[96:99], v[216:219], v[52:55]
    v_mfma_f32_16x16x32_bf16 v[56:59], v[100:103], v[216:219], v[56:59]
    v_mfma_f32_16x16x32_bf16 v[60:63], v[104:107], v[216:219], v[60:63]
    v_mfma_f32_16x16x32_bf16 v[64:67], v[108:111], v[216:219], v[64:67]
    v_mfma_f32_16x16x32_bf16 v[68:71], v[112:115], v[216:219], v[68:71]
    v_mfma_f32_16x16x32_bf16 v[72:75], v[116:119], v[216:219], v[72:75]
    v_mfma_f32_16x16x32_bf16 v[76:79], v[120:123], v[216:219], v[76:79]
    v_mfma_f32_16x16x32_bf16 v[56:59], v[80:83], v[220:223], v[56:59]
    v_mfma_f32_16x16x32_bf16 v[60:63], v[84:87], v[220:223], v[60:63]
    v_mfma_f32_16x16x32_bf16 v[64:67], v[88:91], v[220:223], v[64:67]
    v_mfma_f32_16x16x32_bf16 v[68:71], v[92:95], v[220:223], v[68:71]
    v_mfma_f32_16x16x32_bf16 v[72:75], v[96:99], v[220:223], v[72:75]
    v_mfma_f32_16x16x32_bf16 v[76:79], v[100:103], v[220:223], v[76:79]
    s_waitcnt lgkmcnt(2)
    v_cmp_ne_u32 vcc, v8, v9
    s_cbranch_vccnz L_pz12
L_np12:
    ds_read2_b32 v[8:9], v6 offset0:0 offset1:7
    ds_read_b128 v[216:219], v10 offset:256
    ds_read_b128 v[220:223], v10 offset:3584
    v_mfma_f32_16x16x32_bf16 v[40:43], v[80:83], v[224:227], v[40:43]
    v_mfma_f32_16x16x32_bf16 v[44:47], v[84:87], v[224:227], v[44:47]
    v_mfma_f32_16x16x32_bf16 v[48:51], v[88:91], v[224:227], v[48:51]
    v_mfma_f32_16x16x32_bf16 v[52:55], v[92:95], v[224:227], v[52:55]
    v_mfma_f32_16x16x32_bf16 v[56:59], v[96:99], v[224:227], v[56:59]
    v_mfma_f32_16x16x32_bf16 v[60:63], v[100:103], v[224:227], v[60:63]
    v_mfma_f32_16x16x32_bf16 v[64:67], v[104:107], v[224:227], v[64:67]
    v_mfma_f32_16x16x32_bf16 v[68:71], v[108:111], v[224:227], v[68:71]
    v_mfma_f32_16x16x32_bf16 v[72:75], v[112:115], v[224:227], v[72:75]
    v_mfma_f32_16x16x32_bf16 v[76:79], v[116:119], v[224:227], v[76:79]
    v_mfma_f32_16x16x32_bf16 v[52:55], v[80:83], v[228:231], v[52:55]
    v_mfma_f32_16x16x32_bf16 v[56:59], v[84:87], v[228:231], v[56:59]
    v_mfma_f32_16x16x32_bf16 v[60:63], v[88:91], v[228:231], v[60:63]
    v_mfma_f32_16x16x32_bf16 v[64:67], v[92:95], v[228:231], v[64:67]
    v_mfma_f32_16x16x32_bf16 v[68:71], v[96:99], v[228:231], v[68:71]
    v_mfma_f32_16x16x32_bf16 v[72:75], v[100:103], v[228:231], v[72:75]
    v_mfma_f32_16x16x32_bf16 v[76:79], v[104:107], v[228:231], v[76:79]
    s_waitcnt lgkmcnt(2)
    v_cmp_ne_u32 vcc, v8, v9
    s_cbranch_vccnz L_pz14
L_np14:
    ds_read2_b32 v[8:9], v6 offset0:0 offset1:7
    ds_read_b128 v[224:227], v10 offset:512
    ds_read_b128 v[228:231], v10 offset:3328
    v_mfma_f32_16x16x32_bf16 v[44:47], v[80:83], v[232:235], v[44:47]
    v_mfma_f32_16x16x32_bf16 v[48:51], v[84:87], v[232:235], v[48:51]
    v_mfma_f32_16x16x32_bf16 v[52:55], v[88:91], v[232:235], v[52:55]
    v_mfma_f32_16x16x32_bf16 v[56:59], v[92:95], v[232:235], v[56:59]
    v_mfma_f32_16x16x32_bf16 v[60:63], v[96:99], v[232:235], v[60:63]
    v_mfma_f32_16x16x32_bf16 v[64:67], v[100:103], v[232:235], v[64:67]
    v_mfma_f32_16x16x32_bf16 v[68:71], v[104:107], v[232:235], v[68:71]
    v_mfma_f32_16x16x32_bf16 v[72:75], v[108:111], v[232:235], v[72:75]
    v_mfma_f32_16x16x32_bf16 v[76:79], v[112:115], v[232:235], v[76:79]
    v_mfma_f32_16x16x32_bf16 v[48:51], v[80:83], v[236:239], v[48:51]
    v_mfma_f32_16x16x32_bf16 v[52:55], v[84:87], v[236:239], v[52:55]
    v_mfma_f32_16x16x32_bf16 v[56:59], v[88:91], v[236:239], v[56:59]
    v_mfma_f32_16x16x32_bf16 v[60:63], v[92:95], v[236:239], v[60:63]
    v_mfma_f32_16x16x32_bf16 v[64:67], v[96:99], v[236:239], v[64:67]
    v_mfma_f32_16x16x32_bf16 v[68:71], v[100:103], v[236:239], v[68:71]
    v_mfma_f32_16x16x32_bf16 v[72:75], v[104:107], v[236:239], v[72:75]
    v_mfma_f32_16x16x32_bf16 v[76:79], v[108:111], v[236:239], v[76:79]
    s_waitcnt lgkmcnt(2)
    v_cmp_ne_u32 vcc, v8, v9
    s_cbranch_vccnz L_pz16
L_np16:
    ds_read2_b32 v[8:9], v6 offset0:0 offset1:7
    ds_read_b128 v[232:235], v10 offset:768
    ds_read_b128 v[236:239], v10 offset:3072
    v_mfma_f32_16x16x32_bf16 v[16:19], v[144:147], v[208:211], v[16:19]
    v_mfma_f32_16x16x32_bf16 v[20:23], v[148:151], v[208:211], v[20:23]
    v_mfma_f32_16x16x32_bf16 v[24:27], v[152:155], v[208:211], v[24:27]
    v_mfma_f32_16x16x32_bf16 v[28:31], v[156:159], v[208:211], v[28:31]
    v_mfma_f32_16x16x32_bf16 v[32:35], v[160:163], v[208:211], v[32:35]
    v_mfma_f32_16x16x32_bf16 v[36:39], v[164:167], v[208:211], v[36:39]
    v_mfma_f32_16x16x32_bf16 v[40:43], v[168:171], v[208:211], v[40:43]
    v_mfma_f32_16x16x32_bf16 v[44:47], v[172:175], v[208:211], v[44:47]
    v_mfma_f32_16x16x32_bf16 v[48:51], v[176:179], v[208:211], v[48:51]
    v_mfma_f32_16x16x32_bf16 v[52:55], v[180:183], v[208:211], v[52:55]
    v_mfma_f32_16x16x32_bf16 v[56:59], v[184:187], v[208:211], v[56:59]
    v_mfma_f32_16x16x32_bf16 v[60:63], v[188:191], v[208:211], v[60:63]
    v_mfma_f32_16x16x32_bf16 v[64:67], v[192:195], v[208:211], v[64:67]
    v_mfma_f32_16x16x32_bf16 v[68:71], v[196:199], v[208:211], v[68:71]
    v_mfma_f32_16x16x32_bf16 v[72:75], v[200:203], v[208:211], v[72:75]
    v_mfma_f32_16x16x32_bf16 v[76:79], v[204:207], v[208:211], v[76:79]
    v_mfma_f32_16x16x32_bf16 v[76:79], v[144:147], v[212:215], v[76:79]
    s_waitcnt lgkmcnt(2)
    v_cmp_ne_u32 vcc, v8, v9
    s_cbranch_vccnz L_pz18
L_np18:
    ds_read2_b32 v[8:9], v6 offset0:0 offset1:7
    ds_read_b128 v[208:211], v10 offset:1024
    ds_read_b128 v[212:215], v10 offset:2816
    v_mfma_f32_16x16x32_bf16 v[20:23], v[144:147], v[216:219], v[20:23]
    v_mfma_f32_16x16x32_bf16 v[24:27], v[148:151], v[216:219], v[24:27]
    v_mfma_f32_16x16x32_bf16 v[28:31], v[152:155], v[216:219], v[28:31]
    v_mfma_f32_16x16x32_bf16 v[32:35], v[156:159], v[216:219], v[32:35]
    v_mfma_f32_16x16x32_bf16 v[36:39], v[160:163], v[216:219], v[36:39]
    v_mfma_f32_16x16x32_bf16 v[40:43], v[164:167], v[216:219], v[40:43]
    v_mfma_f32_16x16x32_bf16 v[44:47], v[168:171], v[216:219], v[44:47]
    v_mfma_f32_16x16x32_bf16 v[48:51], v[172:175], v[216:219], v[48:51]
    v_mfma_f32_16x16x32_bf16 v[52:55], v[176:179], v[216:219], v[52:55]
    v_mfma_f32_16x16x32_bf16 v[56:59], v[180:183], v[216:219], v[56:59]
    v_mfma_f32_16x16x32_bf16 v[60:63], v[184:187], v[216:219], v[60:63]
    v_mfma_f32_16x16x32_bf16 v[64:67], v[188:191], v[216:219], v[64:67]
    v_mfma_f32_16x16x32_bf16 v[68:71], v[192:195], v[216:219], v[68:71]
    v_mfma_f32_16x16x32_bf16 v[72:75], v[196:199], v[216:219], v[72:75]
    v_mfma_f32_16x16x32_bf16 v[76:79], v[200:203], v[216:219], v[76:79]
    v_mfma_f32_16x16x32_bf16 v[72:75], v[144:147], v[220:223], v[72:75]
    v_mfma_f32_16x16x32_bf16 v[76:79], v[148:151], v[220:223], v[76:79]
    s_waitcnt lgkmcnt(2)
    v_cmp_ne_u32 vcc, v8, v9
    s_cbranch_vccnz L_pz20
L_np20:
    ds_read2_b32 v[8:9], v6 offset0:0 offset1:7
    ds_read_b128 v[216:219], v10 offset:1280
    ds_read_b128 v[220:223], v10 offset:2560
    v_mfma_f32_16x16x32_bf16 v[24:27], v[144:147], v[224:227], v[24:27]
    v_mfma_f32_16x16x32_bf16 v[28:31], v[148:151], v[224:227], v[28:31]
    v_mfma_f32_16x16x32_bf16 v[32:35], v[152:155], v[224:227], v[32:35]
    v_mfma_f32_16x16x32_bf16 v[36:39], v[156:159], v[224:227], v[36:39]
    v_mfma_f32_16x16x32_bf16 v[40:43], v[160:163], v[224:227], v[40:43]
    v_mfma_f32_16x16x32_bf16 v[44:47], v[164:167], v[224:227], v[44:47]
    v_mfma_f32_16x16x32_bf16 v[48:51], v[168:171], v[224:227], v[48:51]
    v_mfma_f32_16x16x32_bf16 v[52:55], v[172:175], v[224:227], v[52:55]
    v_mfma_f32_16x16x32_bf16 v[56:59], v[176:179], v[224:227], v[56:59]
    v_mfma_f32_16x16x32_bf16 v[60:63], v[180:183], v[224:227], v[60:63]
    v_mfma_f32_16x16x32_bf16 v[64:67], v[184:187], v[224:227], v[64:67]
    v_mfma_f32_16x16x32_bf16 v[68:71], v[188:191], v[224:227], v[68:71]
    v_mfma_f32_16x16x32_bf16 v[72:75], v[192:195], v[224:227], v[72:75]
    v_mfma_f32_16x16x32_bf16 v[76:79], v[196:199], v[224:227], v[76:79]
    v_mfma_f32_16x16x32_bf16 v[68:71], v[144:147], v[228:231], v[68:71]
    v_mfma_f32_16x16x32_bf16 v[72:75], v[148:151], v[228:231], v[72:75]
    v_mfma_f32_16x16x32_bf16 v[76:79], v[152:155], v[228:231], v[76:79]
    s_waitcnt lgkmcnt(2)
    v_cmp_ne_u32 vcc, v8, v9
    s_cbranch_vccnz L_pz22
L_np22:
    ds_read2_b32 v[8:9], v6 offset0:0 offset1:7
    ds_read_b128 v[224:227], v10 offset:1536
    ds_read_b128 v[228:231], v10 offset:2304
    v_mfma_f32_16x16x32_bf16 v[28:31], v[144:147], v[232:235], v[28:31]
    v_mfma_f32_16x16x32_bf16 v[32:35], v[148:151], v[232:235], v[32:35]
    v_mfma_f32_16x16x32_bf16 v[36:39], v[152:155], v[232:235], v[36:39]
    v_mfma_f32_16x16x32_bf16 v[40:43], v[156:159], v[232:235], v[40:43]
    v_mfma_f32_16x16x32_bf16 v[44:47], v[160:163], v[232:235], v[44:47]
    v_mfma_f32_16x16x32_bf16 v[48:51], v[164:167], v[232:235], v[48:51]
    v_mfma_f32_16x16x32_bf16 v[52:55], v[168:171], v[232:235], v[52:55]
    v_mfma_f32_16x16x32_bf16 v[56:59], v[172:175], v[232:235], v[56:59]
    v_mfma_f32_16x16x32_bf16 v[60:63], v[176:179], v[232:235], v[60:63]
    v_mfma_f32_16x16x32_bf16 v[64:67], v[180:183], v[232:235], v[64:67]
    v_mfma_f32_16x16x32_bf16 v[68:71], v[184:187], v[232:235], v[68:71]
    v_mfma_f32_16x16x32_bf16 v[72:75], v[188:191], v[232:235], v[72:75]
    v_mfma_f32_16x16x32_bf16 v[76:79], v[192:195], v[232:235], v[76:79]
    v_mfma_f32_16x16x32_bf16 v[64:67], v[144:147], v[236:239], v[64:67]
    v_mfma_f32_16x16x32_bf16 v[68:71], v[148:151], v[236:239], v[68:71]
    v_mfma_f32_16x16x32_bf16 v[72:75], v[152:155], v[236:239], v[72:75]
    v_mfma_f32_16x16x32_bf16 v[76:79], v[156:159], v[236:239], v[76:79]
    s_waitcnt lgkmcnt(2)
    v_cmp_ne_u32 vcc, v8, v9
    s_cbranch_vccnz L_pz24
L_np24:
    ds_read2_b32 v[8:9], v6 offset0:0 offset1:7
    ds_read_b128 v[232:235], v10 offset:1792
    ds_read_b128 v[236:239], v10 offset:2048
    v_mfma_f32_16x16x32_bf16 v[32:35], v[144:147], v[208:211], v[32:35]
    v_mfma_f32_16x16x32_bf16 v[36:39], v[148:151], v[208:211], v[36:39]
    v_mfma_f32_16x16x32_bf16 v[40:43], v[152:155], v[208:211], v[40:43]
    v_mfma_f32_16x16x32_bf16 v[44:47], v[156:159], v[208:211], v[44:47]
    v_mfma_f32_16x16x32_bf16 v[48:51], v[160:163], v[208:211], v[48:51]
    v_mfma_f32_16x16x32_bf16 v[52:55], v[164:167], v[208:211], v[52:55]
    v_mfma_f32_16x16x32_bf16 v[56:59], v[168:171], v[208:211], v[56:59]
    v_mfma_f32_16x16x32_bf16 v[60:63], v[172:175], v[208:211], v[60:63]
    v_mfma_f32_16x16x32_bf16 v[64:67], v[176:179], v[208:211], v[64:67]
    v_mfma_f32_16x16x32_bf16 v[68:71], v[180:183], v[208:211], v[68:71]
    v_mfma_f32_16x16x32_bf16 v[72:75], v[184:187], v[208:211], v[72:75]
    v_mfma_f32_16x16x32_bf16 v[76:79], v[188:191], v[208:211], v[76:79]
    v_mfma_f32_16x16x32_bf16 v[60:63], v[144:147], v[212:215], v[60:63]
    v_mfma_f32_16x16x32_bf16 v[64:67], v[148:151], v[212:215], v[64:67]
    v_mfma_f32_16x16x32_bf16 v[68:71], v[152:155], v[212:215], v[68:71]
    v_mfma_f32_16x16x32_bf16 v[72:75], v[156:159], v[212:215], v[72:75]
    v_mfma_f32_16x16x32_bf16 v[76:79], v[160:163], v[212:215], v[76:79]
    s_waitcnt lgkmcnt(2)
    v_cmp_ne_u32 vcc, v8, v9
    s_cbranch_vccnz L_pz26
L_np26:
    ds_read2_b32 v[8:9], v6 offset0:0 offset1:7
    v_mfma_f32_16x16x32_bf16 v[36:39], v[144:147], v[216:219], v[36:39]
    v_mfma_f32_16x16x32_bf16 v[40:43], v[148:151], v[216:219], v[40:43]
    v_mfma_f32_16x16x32_bf16 v[44:47], v[152:155], v[216:219], v[44:47]
    v_mfma_f32_16x16x32_bf16 v[48:51], v[156:159], v[216:219], v[48:51]
    v_mfma_f32_16x16x32_bf16 v[52:55], v[160:163], v[216:219], v[52:55]
    v_mfma_f32_16x16x32_bf16 v[56:59], v[164:167], v[216:219], v[56:59]
    v_mfma_f32_16x16x32_bf16 v[60:63], v[168:171], v[216:219], v[60:63]
    v_mfma_f32_16x16x32_bf16 v[64:67], v[172:175], v[216:219], v[64:67]
    v_mfma_f32_16x16x32_bf16 v[68:71], v[176:179], v[216:219], v[68:71]
    v_mfma_f32_16x16x32_bf16 v[72:75], v[180:183], v[216:219], v[72:75]
    v_mfma_f32_16x16x32_bf16 v[76:79], v[184:187], v[216:219], v[76:79]
    v_mfma_f32_16x16x32_bf16 v[56:59], v[144:147], v[220:223], v[56:59]
    v_mfma_f32_16x16x32_bf16 v[60:63], v[148:151], v[220:223], v[60:63]
    v_mfma_f32_16x16x32_bf16 v[64:67], v[152:155], v[220:223], v[64:67]
    v_mfma_f32_16x16x32_bf16 v[68:71], v[156:159], v[220:223], v[68:71]
    v_mfma_f32_16x16x32_bf16 v[72:75], v[160:163], v[220:223], v[72:75]
    v_mfma_f32_16x16x32_bf16 v[76:79], v[164:167], v[220:223], v[76:79]
    s_waitcnt lgkmcnt(0)
    v_cmp_ne_u32 vcc, v8, v9
    s_cbranch_vccnz L_pz28
L_np28:
    ds_read2_b32 v[8:9], v6 offset0:0 offset1:7
    v_mfma_f32_16x16x32_bf16 v[40:43], v[144:147], v[224:227], v[40:43]
    v_mfma_f32_16x16x32_bf16 v[44:47], v[148:151], v[224:227], v[44:47]
    v_mfma_f32_16x16x32_bf16 v[48:51], v[152:155], v[224:227], v[48:51]
    v_mfma_f32_16x16x32_bf16 v[52:55], v[156:159], v[224:227], v[52:55]
    v_mfma_f32_16x16x32_bf16 v[56:59], v[160:163], v[224:227], v[56:59]
    v_mfma_f32_16x16x32_bf16 v[60:63], v[164:167], v[224:227], v[60:63]
    v_mfma_f32_16x16x32_bf16 v[64:67], v[168:171], v[224:227], v[64:67]
    v_mfma_f32_16x16x32_bf16 v[68:71], v[172:175], v[224:227], v[68:71]
    v_mfma_f32_16x16x32_bf16 v[72:75], v[176:179], v[224:227], v[72:75]
    v_mfma_f32_16x16x32_bf16 v[76:79], v[180:183], v[224:227], v[76:79]
    v_mfma_f32_16x16x32_bf16 v[52:55], v[144:147], v[228:231], v[52:55]
    v_mfma_f32_16x16x32_bf16 v[56:59], v[148:151], v[228:231], v[56:59]
    v_mfma_f32_16x16x32_bf16 v[60:63], v[152:155], v[228:231], v[60:63]
    v_mfma_f32_16x16x32_bf16 v[64:67], v[156:159], v[228:231], v[64:67]
    v_mfma_f32_16x16x32_bf16 v[68:71], v[160:163], v[228:231], v[68:71]
    v_mfma_f32_16x16x32_bf16 v[72:75], v[164:167], v[228:231], v[72:75]
    v_mfma_f32_16x16x32_bf16 v[76:79], v[168:171], v[228:231], v[76:79]
    s_waitcnt lgkmcnt(0)
    v_cmp_ne_u32 vcc, v8, v9
    s_cbranch_vccnz L_pz30
L_np30:
    v_mfma_f32_16x16x32_bf16 v[44:47], v[144:147], v[232:235], v[44:47]
    v_mfma_f32_16x16x32_bf16 v[48:51], v[148:151], v[232:235], v[48:51]
    v_mfma_f32_16x16x32_bf16 v[52:55], v[152:155], v[232:235], v[52:55]
    v_mfma_f32_16x16x32_bf16 v[56:59], v[156:159], v[232:235], v[56:59]
    v_mfma_f32_16x16x32_bf16 v[60:63], v[160:163], v[232:235], v[60:63]
    v_mfma_f32_16x16x32_bf16 v[64:67], v[164:167], v[232:235], v[64:67]
    v_mfma_f32_16x16x32_bf16 v[68:71], v[168:171], v[232:235], v[68:71]
    v_mfma_f32_16x16x32_bf16 v[72:75], v[172:175], v[232:235], v[72:75]
    v_mfma_f32_16x16x32_bf16 v[76:79], v[176:179], v[232:235], v[76:79]
    v_mfma_f32_16x16x32_bf16 v[48:51], v[144:147], v[236:239], v[48:51]
    v_mfma_f32_16x16x32_bf16 v[52:55], v[148:151], v[236:239], v[52:55]
    v_mfma_f32_16x16x32_bf16 v[56:59], v[152:155], v[236:239], v[56:59]
    v_mfma_f32_16x16x32_bf16 v[60:63], v[156:159], v[236:239], v[60:63]
    v_mfma_f32_16x16x32_bf16 v[64:67], v[160:163], v[236:239], v[64:67]
    v_mfma_f32_16x16x32_bf16 v[68:71], v[164:167], v[236:239], v[68:71]
    v_mfma_f32_16x16x32_bf16 v[72:75], v[168:171], v[236:239], v[72:75]
    v_mfma_f32_16x16x32_bf16 v[76:79], v[172:175], v[236:239], v[76:79]
    s_setprio 3
    v_mov_b32 v100, 0
    v_mov_b32 v101, 0
    v_mov_b32 v102, 0
    v_mov_b32 v103, 0
    v_permlane32_swap_b32 v16, v48
    v_permlane32_swap_b32 v17, v49
    v_permlane32_swap_b32 v18, v50
    v_permlane32_swap_b32 v19, v51
    v_permlane32_swap_b32 v20, v52
    v_permlane32_swap_b32 v21, v53
    v_permlane32_swap_b32 v22, v54
    v_permlane32_swap_b32 v23, v55
    v_permlane32_swap_b32 v24, v56
    v_permlane32_swap_b32 v25, v57
    v_permlane32_swap_b32 v26, v58
    v_permlane32_swap_b32 v27, v59
    v_permlane32_swap_b32 v28, v60
    v_permlane32_swap_b32 v29, v61
    v_permlane32_swap_b32 v30, v62
    v_permlane32_swap_b32 v31, v63
    v_permlane32_swap_b32 v32, v64
    v_permlane32_swap_b32 v33, v65
    v_permlane32_swap_b32 v34, v66
    v_permlane32_swap_b32 v35, v67
    v_permlane32_swap_b32 v36, v68
    v_permlane32_swap_b32 v37, v69
    v_permlane32_swap_b32 v38, v70
    v_permlane32_swap_b32 v39, v71
    v_permlane32_swap_b32 v40, v72
    v_permlane32_swap_b32 v41, v73
    v_permlane32_swap_b32 v42, v74
    v_permlane32_swap_b32 v43, v75
    v_permlane32_swap_b32 v44, v76
    v_permlane32_swap_b32 v45, v77
    v_permlane32_swap_b32 v46, v78
    v_permlane32_swap_b32 v47, v79
    v_mov_b32 v104, v76
    v_mov_b32 v105, v77
    v_mov_b32 v106, v78
    v_mov_b32 v107, v79
    v_add_f32_dpp v16, v48, v16 row_shr:1 row_mask:0xf bank_mask:0xf bound_ctrl:0
    v_add_f32_dpp v17, v49, v17 row_shr:1 row_mask:0xf bank_mask:0xf bound_ctrl:0
    v_add_f32_dpp v18, v50, v18 row_shr:1 row_mask:0xf bank_mask:0xf bound_ctrl:0
    v_add_f32_dpp v19, v51, v19 row_shr:1 row_mask:0xf bank_mask:0xf bound_ctrl:0
    v_permlane32_swap_b32 v100, v104
    v_permlane32_swap_b32 v101, v105
    v_permlane32_swap_b32 v102, v106
    v_permlane32_swap_b32 v103, v107
    v_add_f32_dpp v20, v52, v20 row_shr:1 row_mask:0xf bank_mask:0xf bound_ctrl:0
    v_add_f32_dpp v21, v53, v21 row_shr:1 row_mask:0xf bank_mask:0xf bound_ctrl:0
    v_add_f32_dpp v22, v54, v22 row_shr:1 row_mask:0xf bank_mask:0xf bound_ctrl:0
    v_add_f32_dpp v23, v55, v23 row_shr:1 row_mask:0xf bank_mask:0xf bound_ctrl:0
    v_add_f32_dpp v24, v56, v24 row_shr:1 row_mask:0xf bank_mask:0xf bound_ctrl:0
    v_add_f32_dpp v25, v57, v25 row_shr:1 row_mask:0xf bank_mask:0xf bound_ctrl:0
    v_add_f32_dpp v26, v58, v26 row_shr:1 row_mask:0xf bank_mask:0xf bound_ctrl:0
    v_add_f32_dpp v27, v59, v27 row_shr:1 row_mask:0xf bank_mask:0xf bound_ctrl:0
    v_add_f32_dpp v28, v60, v28 row_shr:1 row_mask:0xf bank_mask:0xf bound_ctrl:0
    v_add_f32_dpp v29, v61, v29 row_shr:1 row_mask:0xf bank_mask:0xf bound_ctrl:0
    v_add_f32_dpp v30, v62, v30 row_shr:1 row_mask:0xf bank_mask:0xf bound_ctrl:0
    v_add_f32_dpp v31, v63, v31 row_shr:1 row_mask:0xf bank_mask:0xf bound_ctrl:0
    v_add_f32_dpp v32, v64, v32 row_shr:1 row_mask:0xf bank_mask:0xf bound_ctrl:0
    v_add_f32_dpp v33, v65, v33 row_shr:1 row_mask:0xf bank_mask:0xf bound_ctrl:0
    v_add_f32_dpp v34, v66, v34 row_shr:1 row_mask:0xf bank_mask:0xf bound_ctrl:0
    v_add_f32_dpp v35, v67, v35 row_shr:1 row_mask:0xf bank_mask:0xf bound_ctrl:0
    v_add_f32_dpp v36, v68, v36 row_shr:1 row_mask:0xf bank_mask:0xf bound_ctrl:0
    v_add_f32_dpp v37, v69, v37 row_shr:1 row_mask:0xf bank_mask:0xf bound_ctrl:0
    v_add_f32_dpp v38, v70, v38 row_shr:1 row_mask:0xf bank_mask:0xf bound_ctrl:0
    v_add_f32_dpp v39, v71, v39 row_shr:1 row_mask:0xf bank_mask:0xf bound_ctrl:0
    v_add_f32_dpp v40, v72, v40 row_shr:1 row_mask:0xf bank_mask:0xf bound_ctrl:0
    v_add_f32_dpp v41, v73, v41 row_shr:1 row_mask:0xf bank_mask:0xf bound_ctrl:0
    v_add_f32_dpp v42, v74, v42 row_shr:1 row_mask:0xf bank_mask:0xf bound_ctrl:0
    v_add_f32_dpp v43, v75, v43 row_shr:1 row_mask:0xf bank_mask:0xf bound_ctrl:0
    v_add_f32_dpp v44, v76, v44 row_shr:1 row_mask:0xf bank_mask:0xf bound_ctrl:0
    v_add_f32_dpp v45, v77, v45 row_shr:1 row_mask:0xf bank_mask:0xf bound_ctrl:0
    v_add_f32_dpp v46, v78, v46 row_shr:1 row_mask:0xf bank_mask:0xf bound_ctrl:0
    v_add_f32_dpp v47, v79, v47 row_shr:1 row_mask:0xf bank_mask:0xf bound_ctrl:0
    v_add_f32_dpp v16, v100, v16 row_shl:15 row_mask:0xf bank_mask:0xf bound_ctrl:0
    v_add_f32_dpp v17, v101, v17 row_shl:15 row_mask:0xf bank_mask:0xf bound_ctrl:0
    v_add_f32_dpp v18, v102, v18 row_shl:15 row_mask:0xf bank_mask:0xf bound_ctrl:0
    v_add_f32_dpp v19, v103, v19 row_shl:15 row_mask:0xf bank_mask:0xf bound_ctrl:0
    v_add_f32_dpp v20, v48, v20 row_shl:15 row_mask:0xf bank_mask:0xf bound_ctrl:0
    v_add_f32_dpp v21, v49, v21 row_shl:15 row_mask:0xf bank_mask:0xf bound_ctrl:0
    v_add_f32_dpp v22, v50, v22 row_shl:15 row_mask:0xf bank_mask:0xf bound_ctrl:0
    v_add_f32_dpp v23, v51, v23 row_shl:15 row_mask:0xf bank_mask:0xf bound_ctrl:0
    v_add_f32_dpp v24, v52, v24 row_shl:15 row_mask:0xf bank_mask:0xf bound_ctrl:0
    v_add_f32_dpp v25, v53, v25 row_shl:15 row_mask:0xf bank_mask:0xf bound_ctrl:0
    v_add_f32_dpp v26, v54, v26 row_shl:15 row_mask:0xf bank_mask:0xf bound_ctrl:0
    v_add_f32_dpp v27, v55, v27 row_shl:15 row_mask:0xf bank_mask:0xf bound_ctrl:0
    v_add_f32_dpp v28, v56, v28 row_shl:15 row_mask:0xf bank_mask:0xf bound_ctrl:0
    v_add_f32_dpp v29, v57, v29 row_shl:15 row_mask:0xf bank_mask:0xf bound_ctrl:0
    v_add_f32_dpp v30, v58, v30 row_shl:15 row_mask:0xf bank_mask:0xf bound_ctrl:0
    v_add_f32_dpp v31, v59, v31 row_shl:15 row_mask:0xf bank_mask:0xf bound_ctrl:0
    v_add_f32_dpp v32, v60, v32 row_shl:15 row_mask:0xf bank_mask:0xf bound_ctrl:0
    v_add_f32_dpp v33, v61, v33 row_shl:15 row_mask:0xf bank_mask:0xf bound_ctrl:0
    v_add_f32_dpp v34, v62, v34 row_shl:15 row_mask:0xf bank_mask:0xf bound_ctrl:0
    v_add_f32_dpp v35, v63, v35 row_shl:15 row_mask:0xf bank_mask:0xf bound_ctrl:0
    v_add_f32_dpp v36, v64, v36 row_shl:15 row_mask:0xf bank_mask:0xf bound_ctrl:0
    v_add_f32_dpp v37, v65, v37 row_shl:15 row_mask:0xf bank_mask:0xf bound_ctrl:0
    v_add_f32_dpp v38, v66, v38 row_shl:15 row_mask:0xf bank_mask:0xf bound_ctrl:0
    v_add_f32_dpp v39, v67, v39 row_shl:15 row_mask:0xf bank_mask:0xf bound_ctrl:0
    v_add_f32_dpp v40, v68, v40 row_shl:15 row_mask:0xf bank_mask:0xf bound_ctrl:0
    v_add_f32_dpp v41, v69, v41 row_shl:15 row_mask:0xf bank_mask:0xf bound_ctrl:0
    v_add_f32_dpp v42, v70, v42 row_shl:15 row_mask:0xf bank_mask:0xf bound_ctrl:0
    v_add_f32_dpp v43, v71, v43 row_shl:15 row_mask:0xf bank_mask:0xf bound_ctrl:0
    v_add_f32_dpp v44, v72, v44 row_shl:15 row_mask:0xf bank_mask:0xf bound_ctrl:0
    v_add_f32_dpp v45, v73, v45 row_shl:15 row_mask:0xf bank_mask:0xf bound_ctrl:0
    v_add_f32_dpp v46, v74, v46 row_shl:15 row_mask:0xf bank_mask:0xf bound_ctrl:0
    v_add_f32_dpp v47, v75, v47 row_shl:15 row_mask:0xf bank_mask:0xf bound_ctrl:0
    v_cvt_pk_bf16_f32 v108, v16, v17
    v_cvt_pk_bf16_f32 v109, v18, v19
    v_cvt_pk_bf16_f32 v110, v20, v21
    v_cvt_pk_bf16_f32 v111, v22, v23
    v_cvt_pk_bf16_f32 v112, v24, v25
    v_cvt_pk_bf16_f32 v113, v26, v27
    v_cvt_pk_bf16_f32 v114, v28, v29
    v_cvt_pk_bf16_f32 v115, v30, v31
    v_cvt_pk_bf16_f32 v116, v32, v33
    v_cvt_pk_bf16_f32 v117, v34, v35
    v_cvt_pk_bf16_f32 v118, v36, v37
    v_cvt_pk_bf16_f32 v119, v38, v39
    v_cvt_pk_bf16_f32 v120, v40, v41
    v_cvt_pk_bf16_f32 v121, v42, v43
    v_cvt_pk_bf16_f32 v122, v44, v45
    v_cvt_pk_bf16_f32 v123, v46, v47
    v_permlane16_swap_b32 v108, v110
    v_permlane16_swap_b32 v109, v111
    v_permlane16_swap_b32 v112, v114
    v_permlane16_swap_b32 v113, v115
    v_permlane16_swap_b32 v116, v118
    v_permlane16_swap_b32 v117, v119
    v_permlane16_swap_b32 v120, v122
    v_permlane16_swap_b32 v121, v123
    s_lshl_b32 s8, s93, 12
    s_add_u32 s8, s8, 0x700000
    buffer_store_dwordx4 v[108:111], v4, s[52:55], s8 offen offset:0 sc1
    buffer_store_dwordx4 v[112:115], v4, s[52:55], s8 offen offset:512 sc1
    buffer_store_dwordx4 v[116:119], v4, s[52:55], s8 offen offset:1024 sc1
    buffer_store_dwordx4 v[120:123], v4, s[52:55], s8 offen offset:1536 sc1
    s_lshl_b32 s9, s4, 10
    s_add_u32 s9, s9, 0xa10000
    v_mov_b32 v12, 48008
    v_mov_b32 v13, 1
    s_and_b32 s10, s5, 1
    s_waitcnt vmcnt(0)
    s_mov_b64 exec, 1
    ds_add_rtn_u32 v13, v12, v13
    s_mov_b64 exec, -1
    s_waitcnt lgkmcnt(0)
    v_readfirstlane_b32 s8, v13
    s_nop 0
    s_add_u32 s8, s8, s10
    s_cmp_lg_u32 s8, 2
    s_cbranch_scc1 L_aux_done
    s_add_u32 s14, s48, s9
    s_addc_u32 s15, s49, 0
    s_mov_b32 s7, 1
    s_atomic_add s7, s[14:15], 0x0
    s_atomic_add s7, s[14:15], 0x80
    s_atomic_add s7, s[14:15], 0x100
    s_atomic_add s7, s[14:15], 0x180
    s_atomic_add s7, s[14:15], 0x200
    s_atomic_add s7, s[14:15], 0x280
    s_atomic_add s7, s[14:15], 0x300
    s_atomic_add s7, s[14:15], 0x380
L_aux_done:
    s_waitcnt vmcnt(0) lgkmcnt(0)
    s_endpgm
L_pz2:
    s_mov_b32 s12, 0x200000
L_pl2:
    s_sleep 1
    ds_read2_b32 v[8:9], v6 offset0:0 offset1:7
    s_sub_u32 s12, s12, 1
    s_cbranch_scc1 L_np2
    s_waitcnt lgkmcnt(0)
    v_cmp_ne_u32 vcc, v8, v9
    s_cbranch_vccnz L_pl2
    s_setprio 3
    s_branch L_np2
L_pz4:
    s_mov_b32 s12, 0x200000
L_pl4:
    s_sleep 1
    ds_read2_b32 v[8:9], v6 offset0:0 offset1:7
    s_sub_u32 s12, s12, 1
    s_cbranch_scc1 L_np4
    s_waitcnt lgkmcnt(0)
    v_cmp_ne_u32 vcc, v8, v9
    s_cbranch_vccnz L_pl4
    s_setprio 3
    s_branch L_np4
L_pz6:
    s_mov_b32 s12, 0x200000
L_pl6:
    s_sleep 1
    ds_read2_b32 v[8:9], v6 offset0:0 offset1:7
    s_sub_u32 s12, s12, 1
    s_cbranch_scc1 L_np6
    s_waitcnt lgkmcnt(0)
    v_cmp_ne_u32 vcc, v8, v9
    s_cbranch_vccnz L_pl6
    s_setprio 3
    s_branch L_np6
L_pz8:
    s_mov_b32 s12, 0x200000
L_pl8:
    s_sleep 1
    ds_read2_b32 v[8:9], v6 offset0:0 offset1:7
    s_sub_u32 s12, s12, 1
    s_cbranch_scc1 L_np8
    s_waitcnt lgkmcnt(0)
    v_cmp_ne_u32 vcc, v8, v9
    s_cbranch_vccnz L_pl8
    s_setprio 3
    s_branch L_np8
L_pz10:
    s_mov_b32 s12, 0x200000
L_pl10:
    s_sleep 1
    ds_read2_b32 v[8:9], v6 offset0:0 offset1:7
    s_sub_u32 s12, s12, 1
    s_cbranch_scc1 L_np10
    s_waitcnt lgkmcnt(0)
    v_cmp_ne_u32 vcc, v8, v9
    s_cbranch_vccnz L_pl10
    s_setprio 3
    s_branch L_np10
L_pz12:
    s_mov_b32 s12, 0x200000
L_pl12:
    s_sleep 1
    ds_read2_b32 v[8:9], v6 offset0:0 offset1:7
    s_sub_u32 s12, s12, 1
    s_cbranch_scc1 L_np12
    s_waitcnt lgkmcnt(0)
    v_cmp_ne_u32 vcc, v8, v9
    s_cbranch_vccnz L_pl12
    s_setprio 3
    s_branch L_np12
L_pz14:
    s_mov_b32 s12, 0x200000
L_pl14:
    s_sleep 1
    ds_read2_b32 v[8:9], v6 offset0:0 offset1:7
    s_sub_u32 s12, s12, 1
    s_cbranch_scc1 L_np14
    s_waitcnt lgkmcnt(0)
    v_cmp_ne_u32 vcc, v8, v9
    s_cbranch_vccnz L_pl14
    s_setprio 3
    s_branch L_np14
L_pz16:
    s_mov_b32 s12, 0x200000
L_pl16:
    s_sleep 1
    ds_read2_b32 v[8:9], v6 offset0:0 offset1:7
    s_sub_u32 s12, s12, 1
    s_cbranch_scc1 L_np16
    s_waitcnt lgkmcnt(0)
    v_cmp_ne_u32 vcc, v8, v9
    s_cbranch_vccnz L_pl16
    s_setprio 3
    s_branch L_np16
L_pz18:
    s_mov_b32 s12, 0x200000
L_pl18:
    s_sleep 1
    ds_read2_b32 v[8:9], v6 offset0:0 offset1:7
    s_sub_u32 s12, s12, 1
    s_cbranch_scc1 L_np18
    s_waitcnt lgkmcnt(0)
    v_cmp_ne_u32 vcc, v8, v9
    s_cbranch_vccnz L_pl18
    s_setprio 3
    s_branch L_np18
L_pz20:
    s_mov_b32 s12, 0x200000
L_pl20:
    s_sleep 1
    ds_read2_b32 v[8:9], v6 offset0:0 offset1:7
    s_sub_u32 s12, s12, 1
    s_cbranch_scc1 L_np20
    s_waitcnt lgkmcnt(0)
    v_cmp_ne_u32 vcc, v8, v9
    s_cbranch_vccnz L_pl20
    s_setprio 3
    s_branch L_np20
L_pz22:
    s_mov_b32 s12, 0x200000
L_pl22:
    s_sleep 1
    ds_read2_b32 v[8:9], v6 offset0:0 offset1:7
    s_sub_u32 s12, s12, 1
    s_cbranch_scc1 L_np22
    s_waitcnt lgkmcnt(0)
    v_cmp_ne_u32 vcc, v8, v9
    s_cbranch_vccnz L_pl22
    s_setprio 3
    s_branch L_np22
L_pz24:
    s_mov_b32 s12, 0x200000
L_pl24:
    s_sleep 1
    ds_read2_b32 v[8:9], v6 offset0:0 offset1:7
    s_sub_u32 s12, s12, 1
    s_cbranch_scc1 L_np24
    s_waitcnt lgkmcnt(0)
    v_cmp_ne_u32 vcc, v8, v9
    s_cbranch_vccnz L_pl24
    s_setprio 3
    s_branch L_np24
L_pz26:
    s_mov_b32 s12, 0x200000
L_pl26:
    s_sleep 1
    ds_read2_b32 v[8:9], v6 offset0:0 offset1:7
    s_sub_u32 s12, s12, 1
    s_cbranch_scc1 L_np26
    s_waitcnt lgkmcnt(0)
    v_cmp_ne_u32 vcc, v8, v9
    s_cbranch_vccnz L_pl26
    s_setprio 3
    s_branch L_np26
L_pz28:
    s_mov_b32 s12, 0x200000
L_pl28:
    s_sleep 1
    ds_read2_b32 v[8:9], v6 offset0:0 offset1:7
    s_sub_u32 s12, s12, 1
    s_cbranch_scc1 L_np28
    s_waitcnt lgkmcnt(0)
    v_cmp_ne_u32 vcc, v8, v9
    s_cbranch_vccnz L_pl28
    s_setprio 3
    s_branch L_np28
L_pz30:
    s_mov_b32 s12, 0x200000
L_pl30:
    s_sleep 1
    ds_read2_b32 v[8:9], v6 offset0:0 offset1:7
    s_sub_u32 s12, s12, 1
    s_cbranch_scc1 L_np30
    s_waitcnt lgkmcnt(0)
    v_cmp_ne_u32 vcc, v8, v9
    s_cbranch_vccnz L_pl30
    s_setprio 3
    s_branch L_np30
L_w7:
    s_and_b32 s8, s4, 1
    s_lshr_b32 s9, s4, 1
    v_mul_u32_u24 v62, 3072, v0
    s_mul_i32 s96, s5, 196608
    s_mul_i32 s10, s5, 26
    s_lshr_b32 s10, s10, 8
    s_mul_i32 s11, s10, 10
    s_sub_u32 s11, s5, s11
    s_mov_b32 s76, s11
    s_mul_i32 s77, s4, 3
    s_add_u32 s97, s77, s3
    s_lshl_b32 s97, s97, 7
    s_add_u32 s96, s96, s97
    s_cmp_ge_u32 s3, 3
    s_cselect_b32 s96, 0x7f000000, s96
    s_add_u32 s77, s77, s10
    s_mul_i32 s97, s11, 410
    s_lshr_b32 s97, s97, 8
    s_mul_i32 s14, s4, 2
    s_add_u32 s97, s97, s14
    s_mul_i32 s14, s10, 0
    s_add_u32 s97, s97, s14
    s_and_b32 s97, s97, 15
    s_lshl_b32 s97, s97, 2
    s_mov_b32 s100, 0x76543210
    s_mov_b32 s101, 0xfedcba98
    s_lshr_b64 s[50:51], s[100:101], s97
    s_sub_u32 s97, 64, s97
    s_lshl_b64 s[100:101], s[100:101], s97
    s_or_b64 s[50:51], s[50:51], s[100:101]
    s_and_b32 s10, s5, 7
    s_lshr_b32 s11, s5, 3
    s_mov_b32 s78, s10
    s_lshl_b32 s79, s4, 2
    s_add_u32 s79, s79, s11
    s_mul_i32 s97, s10, 3
    s_mul_i32 s14, s4, 3
    s_add_u32 s97, s97, s14
    s_mul_i32 s14, s11, 0
    s_add_u32 s97, s97, s14
    s_lshr_b32 s97, s97, 1
    s_mul_i32 s14, s97, 43
    s_lshr_b32 s14, s14, 9
    s_mul_i32 s14, s14, 12
    s_sub_u32 s97, s97, s14
    s_mov_b32 s91, 0x76543210
    s_mov_b32 s92, 0xba98
    s_cmp_eq_u32 s97, 1
    s_cselect_b32 s91, 0x87654321, s91
    s_cselect_b32 s92, 0xba9, s92
    s_cmp_eq_u32 s97, 2
    s_cselect_b32 s91, 0x98765432, s91
    s_cselect_b32 s92, 0x10ba, s92
    s_cmp_eq_u32 s97, 3
    s_cselect_b32 s91, 0xa9876543, s91
    s_cselect_b32 s92, 0x210b, s92
    s_cmp_eq_u32 s97, 4
    s_cselect_b32 s91, 0xba987654, s91
    s_cselect_b32 s92, 0x3210, s92
    s_cmp_eq_u32 s97, 5
    s_cselect_b32 s91, 0xba98765, s91
    s_cselect_b32 s92, 0x4321, s92
    s_cmp_eq_u32 s97, 6
    s_cselect_b32 s91, 0x10ba9876, s91
    s_cselect_b32 s92, 0x5432, s92
    s_cmp_eq_u32 s97, 7
    s_cselect_b32 s91, 0x210ba987, s91
    s_cselect_b32 s92, 0x6543, s92
    s_cmp_eq_u32 s97, 8
    s_cselect_b32 s91, 0x3210ba98, s91
    s_cselect_b32 s92, 0x7654, s92
    s_cmp_eq_u32 s97, 9
    s_cselect_b32 s91, 0x43210ba9, s91
    s_cselect_b32 s92, 0x8765, s92
    s_cmp_eq_u32 s97, 10
    s_cselect_b32 s91, 0x543210ba, s91
    s_cselect_b32 s92, 0x9876, s92
    s_cmp_eq_u32 s97, 11
    s_cselect_b32 s91, 0x6543210b, s91
    s_cselect_b32 s92, 0xa987, s92
    v_lshrrev_b32 v8, 2, v0
    v_and_b32 v9, 3, v0
    v_mul_u32_u24 v5, 10240, v8
    v_lshl_add_u32 v5, v9, 4, v5
    v_mul_u32_u24 v4, 12576, v9
    v_lshl_add_u32 v4, v8, 4, v4
    s_lshl_b32 s96, s93, 4
    s_add_u32 s96, s96, 0x0
    v_lshrrev_b32 v7, 1, v0
    v_lshlrev_b32 v7, 5, v7
    v_and_b32 v13, 16, v2
    v_add_u32 v7, v7, v13
    s_and_b32 s11, s5, 1
    s_cmp_eq_u32 s11, 0
    s_mov_b32 s10, 0x33333333
    s_cselect_b32 s100, 0x77777777, s10
    s_mov_b32 s101, s100
    s_setprio 3
    s_lshl_b32 s9, s2, 10
    s_add_u32 s9, s9, 0xa80000
    s_add_u32 s14, s48, s9
    s_addc_u32 s15, s49, 0
    s_mov_b32 s12, 65536
L_p4:
    s_load_dword s87, s[14:15], 0 glc
    s_load_dword s88, s[14:15], 128 glc
    s_load_dword s89, s[14:15], 256 glc
    s_load_dword s90, s[14:15], 384 glc
    s_waitcnt lgkmcnt(0)
    s_xor_b32 s87, s87, s6
    s_xor_b32 s88, s88, s6
    s_xor_b32 s89, s89, s6
    s_xor_b32 s90, s90, s6
    s_or_b32 s87, s87, s88
    s_or_b32 s89, s89, s90
    s_or_b32 s87, s87, s89
    s_cbranch_scc0 L_p4ok
    s_sub_u32 s12, s12, 1
    s_cmp_lg_u32 s12, 0
    s_cbranch_scc1 L_p4
L_p4ok:
    s_mov_b32 s10, 0xa40000
    buffer_load_dwordx4 v[80:83], v7, s[52:55], s10 offen sc1
    s_mov_b32 s10, 0xa40400
    buffer_load_dwordx4 v[84:87], v7, s[52:55], s10 offen sc1
    s_mov_b32 s10, 0xa40800
    buffer_load_dwordx4 v[88:91], v7, s[52:55], s10 offen sc1
    s_mov_b32 s10, 0xa40c00
    buffer_load_dwordx4 v[92:95], v7, s[52:55], s10 offen sc1
    s_mov_b32 s10, 0xa41000
    buffer_load_dwordx4 v[96:99], v7, s[52:55], s10 offen sc1
    s_mov_b32 s10, 0xa41400
    buffer_load_dwordx4 v[100:103], v7, s[52:55], s10 offen sc1
    s_mov_b32 s10, 0xa41800
    buffer_load_dwordx4 v[104:107], v7, s[52:55], s10 offen sc1
    s_mov_b32 s10, 0xa41c00
    buffer_load_dwordx4 v[108:111], v7, s[52:55], s10 offen sc1
    s_mov_b64 exec, s[100:101]
    buffer_load_dwordx4 v[16:19], v5, s[52:55], s96 offen sc1
    s_add_u32 s96, s96, 163840
    buffer_load_dwordx4 v[20:23], v5, s[52:55], s96 offen sc1
    s_add_u32 s96, s96, 163840
    buffer_load_dwordx4 v[24:27], v5, s[52:55], s96 offen sc1
    s_add_u32 s96, s96, 163840
    buffer_load_dwordx4 v[28:31], v5, s[52:55], s96 offen sc1
    s_add_u32 s96, s96, 163840
    buffer_load_dwordx4 v[32:35], v5, s[52:55], s96 offen sc1
    s_add_u32 s96, s96, 163840
    buffer_load_dwordx4 v[36:39], v5, s[52:55], s96 offen sc1
    s_add_u32 s96, s96, 163840
    buffer_load_dwordx4 v[40:43], v5, s[52:55], s96 offen sc1
    s_add_u32 s96, s96, 163840
    buffer_load_dwordx4 v[44:47], v5, s[52:55], s96 offen sc1
    s_add_u32 s96, s96, 163840
    buffer_load_dwordx4 v[48:51], v5, s[52:55], s96 offen sc1
    s_add_u32 s96, s96, 163840
    buffer_load_dwordx4 v[52:55], v5, s[52:55], s96 offen sc1
    s_add_u32 s96, s96, 163840
    buffer_load_dwordx4 v[56:59], v5, s[52:55], s96 offen sc1
    s_add_u32 s96, s96, 163840
    buffer_load_dwordx4 v[60:63], v5, s[52:55], s96 offen sc1
    s_add_u32 s96, s96, 163840
    buffer_load_dwordx4 v[64:67], v5, s[52:55], s96 offen sc1
    s_add_u32 s96, s96, 163840
    buffer_load_dwordx4 v[68:71], v5, s[52:55], s96 offen sc1
    s_add_u32 s96, s96, 163840
    buffer_load_dwordx4 v[72:75], v5, s[52:55], s96 offen sc1
    s_add_u32 s96, s96, 163840
    buffer_load_dwordx4 v[76:79], v5, s[52:55], s96 offen sc1
    s_mov_b64 exec, -1
    s_cmp_lg_u32 s2, 0
    s_cbranch_scc1 L_noE
    s_add_u32 s14, s48, 0xa60000
    s_addc_u32 s15, s49, 0
    s_mov_b32 s7, s6
    s_atomic_swap s7, s[14:15], 0
    s_waitcnt lgkmcnt(0)
L_noE:
    s_waitcnt vmcnt(23)
    ds_write_b128 v2, v[80:83] offset:37728
    s_waitcnt vmcnt(22)
    ds_write_b128 v2, v[84:87] offset:38752
    s_waitcnt vmcnt(21)
    ds_write_b128 v2, v[88:91] offset:39776
    s_waitcnt vmcnt(20)
    ds_write_b128 v2, v[92:95] offset:40800
    s_waitcnt vmcnt(19)
    ds_write_b128 v2, v[96:99] offset:41824
    s_waitcnt vmcnt(18)
    ds_write_b128 v2, v[100:103] offset:42848
    s_waitcnt vmcnt(17)
    ds_write_b128 v2, v[104:107] offset:43872
    s_waitcnt vmcnt(16)
    ds_write_b128 v2, v[108:111] offset:44896
    v_mov_b32 v12, 48016
    v_mov_b32 v13, 1
    s_mov_b64 exec, 1
    ds_add_u32 v12, v13
    s_mov_b64 exec, -1
    s_mov_b64 exec, s[100:101]
    s_waitcnt vmcnt(15)
    ds_write_b128 v4, v[16:19] offset:8480
    s_waitcnt vmcnt(14)
    ds_write_b128 v4, v[20:23] offset:8736
    s_waitcnt vmcnt(13)
    ds_write_b128 v4, v[24:27] offset:8992
    s_waitcnt vmcnt(12)
    ds_write_b128 v4, v[28:31] offset:9248
    s_waitcnt vmcnt(11)
    ds_write_b128 v4, v[32:35] offset:9504
    s_waitcnt vmcnt(10)
    ds_write_b128 v4, v[36:39] offset:9760
    s_waitcnt vmcnt(9)
    ds_write_b128 v4, v[40:43] offset:10016
    s_waitcnt vmcnt(8)
    ds_write_b128 v4, v[44:47] offset:10272
    s_waitcnt vmcnt(7)
    ds_write_b128 v4, v[48:51] offset:10528
    s_waitcnt vmcnt(6)
    ds_write_b128 v4, v[52:55] offset:10784
    s_waitcnt vmcnt(5)
    ds_write_b128 v4, v[56:59] offset:11040
    s_waitcnt vmcnt(4)
    ds_write_b128 v4, v[60:63] offset:11296
    s_waitcnt vmcnt(3)
    ds_write_b128 v4, v[64:67] offset:11552
    s_waitcnt vmcnt(2)
    ds_write_b128 v4, v[68:71] offset:11808
    s_waitcnt vmcnt(1)
    ds_write_b128 v4, v[72:75] offset:12064
    s_waitcnt vmcnt(0)
    ds_write_b128 v4, v[76:79] offset:12320
    s_mov_b64 exec, -1
    s_waitcnt lgkmcnt(0)
    v_mov_b32 v12, 47992
    v_mov_b32 v13, 1
    s_mov_b64 exec, 1
    ds_add_u32 v12, v13
    s_mov_b64 exec, -1
    s_and_b32 s11, s5, 1
    s_sub_u32 s11, 3, s11
    v_mov_b32 v10, 48012
    s_mov_b32 s12, 0x200000
L_lw6:
    ds_read_b32 v11, v10
    s_waitcnt lgkmcnt(0)
    v_readfirstlane_b32 s8, v11
    s_nop 0
    s_cmp_ge_u32 s8, s11
    s_cbranch_scc1 L_lwok6
    s_sleep 2
    s_sub_u32 s12, s12, 1
    s_cmp_lg_u32 s12, 0
    s_cbranch_scc1 L_lw6
L_lwok6:
    s_cmp_ge_u32 s5, 30
    s_cbranch_scc1 L_yw
    v_mov_b32 v10, 47996
    s_mov_b32 s12, 0x200000
L_lw7:
    ds_read_b32 v11, v10
    s_waitcnt lgkmcnt(0)
    v_readfirstlane_b32 s8, v11
    s_nop 0
    s_cmp_ge_u32 s8, 4
    s_cbranch_scc1 L_lwok7
    s_sleep 8
    s_sub_u32 s12, s12, 1
    s_cmp_lg_u32 s12, 0
    s_cbranch_scc1 L_lw7
L_lwok7:
L_yw:
    s_and_b32 s9, s2, 63
    s_lshl_b32 s9, s9, 7
    s_add_u32 s9, s9, 0xa10000
    s_add_u32 s14, s48, s9
    s_addc_u32 s15, s49, 0
    s_mov_b32 s12, 65536
L_sp4:
    s_load_dword s7, s[14:15], 0 glc
L_sq4:
    s_waitcnt lgkmcnt(0)
    s_cmp_eq_u32 s7, 32
    s_cbranch_scc1 L_spok4
    s_sleep 2
    s_sub_u32 s12, s12, 1
    s_cmp_lg_u32 s12, 0
    s_cbranch_scc1 L_sp4
L_spok4:
    v_lshrrev_b32 v8, 3, v0
    v_lshlrev_b32 v8, 12, v8
    v_and_b32 v9, 7, v0
    v_lshl_add_u32 v8, v9, 4, v8
    s_mul_i32 s8, s78, 327680
    s_lshl_b32 s9, s79, 7
    s_add_u32 s8, s8, s9
    s_add_u32 s8, s8, 0x700000
    buffer_load_dwordx4 v[16:19], v8, s[52:55], s8 offen sc1
    s_add_u32 s8, s8, 32768
    buffer_load_dwordx4 v[20:23], v8, s[52:55], s8 offen sc1
    s_add_u32 s8, s8, 32768
    buffer_load_dwordx4 v[24:27], v8, s[52:55], s8 offen sc1
    s_add_u32 s8, s8, 32768
    buffer_load_dwordx4 v[28:31], v8, s[52:55], s8 offen sc1
    s_add_u32 s8, s8, 32768
    buffer_load_dwordx4 v[32:35], v8, s[52:55], s8 offen sc1
    s_add_u32 s8, s8, 32768
    buffer_load_dwordx4 v[36:39], v8, s[52:55], s8 offen sc1
    s_add_u32 s8, s8, 32768
    buffer_load_dwordx4 v[40:43], v8, s[52:55], s8 offen sc1
    s_add_u32 s8, s8, 32768
    buffer_load_dwordx4 v[44:47], v8, s[52:55], s8 offen sc1
    s_add_u32 s8, s8, 32768
    buffer_load_dwordx4 v[48:51], v8, s[52:55], s8 offen sc1
    s_add_u32 s8, s8, 32768
    buffer_load_dwordx4 v[52:55], v8, s[52:55], s8 offen sc1
    s_waitcnt vmcnt(9)
    ds_write_b128 v2, v[16:19] offset:37728
    s_waitcnt vmcnt(8)
    ds_write_b128 v2, v[20:23] offset:38752
    s_waitcnt vmcnt(7)
    ds_write_b128 v2, v[24:27] offset:39776
    s_waitcnt vmcnt(6)
    ds_write_b128 v2, v[28:31] offset:40800
    s_waitcnt vmcnt(5)
    ds_write_b128 v2, v[32:35] offset:41824
    s_waitcnt vmcnt(4)
    ds_write_b128 v2, v[36:39] offset:42848
    s_waitcnt vmcnt(3)
    ds_write_b128 v2, v[40:43] offset:43872
    s_waitcnt vmcnt(2)
    ds_write_b128 v2, v[44:47] offset:44896
    s_waitcnt vmcnt(1)
    ds_write_b128 v2, v[48:51] offset:45920
    s_waitcnt vmcnt(0)
    ds_write_b128 v2, v[52:55] offset:46944
    s_waitcnt vmcnt(0) lgkmcnt(0)
    s_endpgm
L_exit:
    s_endpgm
L_code_end:
.section .rodata,"a"
.p2align 6
.amdhsa_kernel parallel_sum__ssm_conv_s4__mixer_token_mlp__prompt_kernel
  .amdhsa_next_free_vgpr 256
  .amdhsa_next_free_sgpr 102
  .amdhsa_accum_offset 256
  .amdhsa_group_segment_fixed_size 0
  .amdhsa_kernarg_size 136
  .amdhsa_user_sgpr_count 2
  .amdhsa_user_sgpr_kernarg_segment_ptr 1
  .amdhsa_system_sgpr_workgroup_id_x 1
  .amdhsa_float_denorm_mode_32 3
.end_amdhsa_kernel
```
